```python
import torch

def _softmax(x, axis=-1):
    return torch.softmax(x, dim=axis)
def _gelu(x):
    return torch.nn.functional.gelu(x, approximate="tanh")
def _silu(x):
    return torch.nn.functional.silu(x)
def _sigmoid(x):
    return torch.sigmoid(x)
def _layernorm(x, axis=-1, eps=1e-5):
    m = x.mean(dim=axis, keepdim=True)
    v = x.var(dim=axis, keepdim=True, unbiased=False)
    return (x - m) / torch.sqrt(v + eps)
def _scatter_add(tgt, idx, src, axis=0):
    return tgt.clone().index_add_(axis, idx, src)
def _segment_sum(src, seg, n):
    out = torch.zeros((n,) + src.shape[1:], dtype=src.dtype)
    return out.index_add_(0, seg, src)
def _pad(x, pw):
    flat = tuple(v for pair in reversed(pw) for v in pair)
    return torch.nn.functional.pad(x, flat)

kernel_name = 'sequential_preLN__spectral_fnet__moe_arch_mod__prompt'

def setup_inputs():

    _w = (lambda a: (lambda t: t.to(torch.bfloat16) if t.is_floating_point() else t)(torch.as_tensor(a)))
    def _A_setup():
        B, S, D = 1, 2048, 640
        ns = torch.arange(S)[:, None] * torch.arange(S)[None, :]
        nd = torch.arange(D)[:, None] * torch.arange(D)[None, :]
        Ws_re = torch.cos(-2.0 * torch.pi * ns / S).to(float)
        Ws_im = torch.sin(-2.0 * torch.pi * ns / S).to(float)
        Wd_re = torch.cos(-2.0 * torch.pi * nd / D).to(float)
        Wd_im = torch.sin(-2.0 * torch.pi * nd / D).to(float)
        return {
            "x": _w((lambda *s: torch.randn(*s, dtype=torch.bfloat16) * 0.05)(B, S, D)),
            "dft_seq_re": _w(Ws_re),
            "dft_seq_im": _w(Ws_im),
            "dft_hid_re": _w(Wd_re),
            "dft_hid_im": _w(Wd_im),
        }
    _A_in = _A_setup()

    def _B_setup():
        B, S, D, F, C = 1, 2048, 640, 1536, 2
        return {
            "x": _w((lambda *s: torch.randn(*s, dtype=torch.bfloat16) * 0.05)(B, S, D)),
            "w_r": _w((lambda *s: torch.randn(*s, dtype=torch.bfloat16) * 1.6)(D)),
            "w_gate": _w((lambda *s: torch.randn(*s, dtype=torch.bfloat16) * 0.4)(D, F)),
            "w_up": _w((lambda *s: torch.randn(*s, dtype=torch.bfloat16) * 0.4)(D, F)),
            "w_down": _w((lambda *s: torch.randn(*s, dtype=torch.bfloat16) * 0.4)(F, D)),
        }
    _B_in = _B_setup()

    return {
        "A_x": _A_in["x"],
        "A_dft_seq_re": _A_in["dft_seq_re"],
        "A_dft_seq_im": _A_in["dft_seq_im"],
        "A_dft_hid_re": _A_in["dft_hid_re"],
        "A_dft_hid_im": _A_in["dft_hid_im"],
        "B_x": _B_in["x"],
        "B_w_r": _B_in["w_r"],
        "B_w_gate": _B_in["w_gate"],
        "B_w_up": _B_in["w_up"],
        "B_w_down": _B_in["w_down"],
    }

def reference(A_x, A_dft_seq_re, A_dft_seq_im, A_dft_hid_re, A_dft_hid_im, B_x, B_w_r, B_w_gate, B_w_up, B_w_down):
    def _A_ref(x, dft_seq_re, dft_seq_im, dft_hid_re, dft_hid_im):
        a = torch.einsum("bsd,ed->bse", x, dft_hid_re)
        b = torch.einsum("bsd,ed->bse", x, dft_hid_im)
        y = torch.einsum("ts,bse->bte", dft_seq_re, a) - torch.einsum("ts,bse->bte", dft_seq_im, b)
        return y

    def _B_ref(x, w_r, w_gate, w_up, w_down):
        B, S, D = x.shape
        C = 2
        r = x @ w_r
        idx = torch.argsort(-r, axis=-1)[:, :C]
        idx_e = (lambda x, n, axis: torch.repeat_interleave(x, n, dim=axis))(idx.reshape(B, C, 1), D, axis=2)
        x_sel = (lambda x, i, axis: torch.take_along_dim(x, i, dim=axis))(x, idx_e, axis=1)
        g = _silu(x_sel @ w_gate)
        u = x_sel @ w_up
        y = (g * u) @ w_down
        r_sel = _sigmoid((lambda x, i, axis: torch.take_along_dim(x, i, dim=axis))(r, idx, axis=1))
        y = y * r_sel.reshape(B, C, 1)
        b_off = (torch.arange(B) * S).reshape(B, 1)
        flat_idx = (idx + b_off).reshape(B * C)
        zero = (x * 0.0).reshape(B * S, D)
        upd = _scatter_add(zero, flat_idx, y.reshape(B * C, D), axis=0)
        return x + upd.reshape(B, S, D)

    x = A_x
    h = x + _A_ref(_layernorm(x, axis=-1), A_dft_seq_re, A_dft_seq_im, A_dft_hid_re, A_dft_hid_im)
    h2 = h + _B_ref(_layernorm(h, axis=-1), B_w_r, B_w_gate, B_w_up, B_w_down)
    return h2
```

```asm
; @launch grid=(256,1,1) block=(384,1,1) lds=152208
.amdgcn_target "amdgcn-amd-amdhsa--gfx950"
.text
.globl sequential_preLN__spectral_fnet__moe_arch_mod__prompt_kernel
.p2align 8
.type sequential_preLN__spectral_fnet__moe_arch_mod__prompt_kernel,@function
sequential_preLN__spectral_fnet__moe_arch_mod__prompt_kernel:
F_beg:
    s_cmp_ge_u32 s2, 256
    s_cbranch_scc1 F_end
    s_load_dwordx2 s[4:5], s[0:1], 0
    s_load_dwordx2 s[56:57], s[0:1], 80
    s_load_dwordx2 s[6:7], s[0:1], 96
    s_load_dwordx2 s[40:41], s[0:1], 48
    s_and_b32 s20, s2, 31
    s_lshr_b32 s21, s2, 5
    v_lshrrev_b32 v1, 6, v0
    s_nop 0
    v_readfirstlane_b32 s22, v1
    s_and_b32 s23, s2, 7
    s_lshr_b32 s24, s2, 3
    s_cmp_lt_u32 s2, 96
    s_cselect_b32 s25, 12, 5
    s_cselect_b32 s26, 0, 12
    s_mul_i32 s23, s23, s25
    s_add_u32 s23, s23, s24
    s_sub_u32 s23, s23, s26
    s_waitcnt lgkmcnt(0)
    s_mov_b32 s8, s4
    s_and_b32 s9, s5, 0xffff
    s_mov_b32 s10, 2621440
    s_mov_b32 s11, 0x20000
    s_mov_b32 s12, s6
    s_and_b32 s13, s7, 0xffff
    s_mov_b32 s14, 3031296
    s_mov_b32 s15, 0x20000
    s_mov_b32 s16, s56
    s_and_b32 s17, s57, 0xffff
    s_mov_b32 s18, 2621440
    s_mov_b32 s19, 0x20000
    s_mov_b32 s44, s40
    s_and_b32 s45, s41, 0xffff
    s_mov_b32 s46, 1280
    s_mov_b32 s47, 0x20000
    s_cmp_eq_u32 s22, 4
    s_cbranch_scc1 F_sync
    s_cmp_eq_u32 s22, 5
    s_cbranch_scc1 F_loader
    v_and_b32 v84, 63, v0
    v_lshrrev_b32 v87, 3, v84
    s_lshl_b32 s24, s22, 4
    v_add_u32 v87, s24, v87
    s_mov_b32 s25, 40960
    s_mul_i32 s26, s20, 1280
    v_and_b32 v88, 7, v84
    v_lshlrev_b32 v89, 4, v88
    v_mad_u32_u24 v82, v87, s25, v89
    s_add_u32 s27, s26, 327680
    buffer_load_dwordx4 v[2:5], v82, s[8:11], s26 offen offset:0
    buffer_load_dwordx4 v[6:9], v82, s[8:11], s26 offen offset:128
    buffer_load_dwordx4 v[10:13], v82, s[8:11], s26 offen offset:256
    buffer_load_dwordx4 v[14:17], v82, s[8:11], s26 offen offset:384
    buffer_load_dwordx4 v[18:21], v82, s[8:11], s26 offen offset:512
    buffer_load_dwordx4 v[22:25], v82, s[8:11], s26 offen offset:640
    buffer_load_dwordx4 v[26:29], v82, s[8:11], s26 offen offset:768
    buffer_load_dwordx4 v[30:33], v82, s[8:11], s26 offen offset:896
    buffer_load_dwordx4 v[34:37], v82, s[8:11], s26 offen offset:1024
    buffer_load_dwordx4 v[38:41], v82, s[8:11], s26 offen offset:1152
    buffer_load_dwordx4 v[42:45], v82, s[8:11], s27 offen offset:0
    buffer_load_dwordx4 v[46:49], v82, s[8:11], s27 offen offset:128
    buffer_load_dwordx4 v[50:53], v82, s[8:11], s27 offen offset:256
    buffer_load_dwordx4 v[54:57], v82, s[8:11], s27 offen offset:384
    buffer_load_dwordx4 v[58:61], v82, s[8:11], s27 offen offset:512
    buffer_load_dwordx4 v[62:65], v82, s[8:11], s27 offen offset:640
    buffer_load_dwordx4 v[66:69], v82, s[8:11], s27 offen offset:768
    buffer_load_dwordx4 v[70:73], v82, s[8:11], s27 offen offset:896
    buffer_load_dwordx4 v[74:77], v82, s[8:11], s27 offen offset:1024
    buffer_load_dwordx4 v[78:81], v82, s[8:11], s27 offen offset:1152
    v_mul_u32_u24 v83, 160, v87
    v_lshrrev_b32 v89, 2, v88
    v_lshl_add_u32 v83, v89, 3, v83
    v_and_b32 v89, 3, v84
    s_lshr_b32 s30, s21, 1
    v_cmp_eq_u32 s[28:29], s30, v89
    v_and_b32 v89, 1, v84
    v_cmp_eq_u32 s[32:33], 1, v89
    v_lshl_add_u32 v89, v89, 3, v87
    v_lshlrev_b32 v95, 2, v89
    v_lshlrev_b32 v96, 1, v89
    v_lshrrev_b32 v85, 4, v84
    v_and_b32 v86, 15, v84
    v_and_b32 v87, 7, v84
    s_lshl_b32 s24, s22, 3
    v_add_u32 v87, s24, v87
    v_lshrrev_b32 v88, 3, v86
    v_lshlrev_b32 v89, 9, v88
    v_mad_u32_u24 v89, v87, s20, v89
    v_mov_b32 v114, 0x80008000
    v_mul_lo_u32 v114, v114, v88
    v_lshl_add_u32 v90, v87, 1, v88
    v_cmp_eq_u32 vcc, 1, v90
    s_nop 1
    v_cndmask_b32_e64 v91, v87, 32, vcc
    v_cndmask_b32_e64 v89, v89, 0, vcc
    v_lshlrev_b32 v92, 7, v85
    v_mad_u32_u24 v89, v91, v92, v89
    v_cvt_f32_u32 v91, v91
    v_cvt_f32_u32 v89, v89
    v_mul_f32 v91, 0x3c800000, v91
    v_mul_f32 v89, 0x3a000000, v89
    v_and_b32 v92, 7, v84
    v_mul_u32_u24 v115, 320, v92
    v_mul_u32_u24 v92, 160, v88
    v_mul_u32_u24 v93, 40, v85
    s_mul_i32 s62, s22, 2560
    s_add_u32 s62, s62, 16384
    v_add3_u32 v115, v115, v92, v93
    v_add_u32 v115, s62, v115
    s_mul_i32 s63, s22, 655360
    s_mul_i32 s24, s20, 2560
    s_add_u32 s63, s63, s24
    s_mul_i32 s24, s21, 320
    s_add_u32 s63, s63, s24
    v_fmamk_f32 v98, v91, 0x0, v89
    v_fmamk_f32 v99, v91, 0x3f800000, v89
    v_fmamk_f32 v100, v91, 0x40000000, v89
    v_fmamk_f32 v101, v91, 0x40400000, v89
    v_fmamk_f32 v102, v91, 0x41800000, v89
    v_fmamk_f32 v103, v91, 0x41880000, v89
    v_fmamk_f32 v104, v91, 0x41900000, v89
    v_fmamk_f32 v105, v91, 0x41980000, v89
    v_fmamk_f32 v106, v91, 0x42000000, v89
    v_fmamk_f32 v107, v91, 0x42040000, v89
    v_fmamk_f32 v108, v91, 0x42080000, v89
    v_fmamk_f32 v109, v91, 0x420c0000, v89
    v_fmamk_f32 v110, v91, 0x42400000, v89
    v_fmamk_f32 v111, v91, 0x42440000, v89
    v_fmamk_f32 v112, v91, 0x42480000, v89
    v_fmamk_f32 v113, v91, 0x424c0000, v89
    v_cos_f32 v98, v98
    v_cos_f32 v99, v99
    v_cos_f32 v100, v100
    v_cos_f32 v101, v101
    v_cos_f32 v102, v102
    v_cos_f32 v103, v103
    v_cos_f32 v104, v104
    v_cos_f32 v105, v105
    v_cos_f32 v106, v106
    v_cos_f32 v107, v107
    v_cos_f32 v108, v108
    v_cos_f32 v109, v109
    v_cos_f32 v110, v110
    v_cos_f32 v111, v111
    v_cos_f32 v112, v112
    v_cos_f32 v113, v113
    v_mov_b32 v183, 0
    v_mov_b32 v187, 0
    v_mov_b32 v191, 0
    v_mov_b32 v195, 0
    v_mov_b32 v199, 0
    v_mov_b32 v203, 0
    v_mov_b32 v207, 0
    v_mov_b32 v211, 0
    s_lshl_b32 s24, s21, 2
    s_add_u32 s24, s24, s22
    v_lshl_add_u32 v87, v85, 5, s24
    v_cvt_f32_u32 v88, v86
    v_cvt_f32_u32 v89, v87
    v_mul_f32 v88, 0x3acccccd, v88
    v_mul_f32 v89, v88, v89
    v_lshlrev_b32 v223, 4, v84
    s_lshl_b32 s24, s22, 11
    v_add_u32 v87, s24, v223
    v_and_b32 v90, 3, v86
    v_cmp_eq_u32 s[34:35], 0, v90
    v_cmp_eq_u32 s[36:37], 1, v90
    v_cmp_eq_u32 s[38:39], 2, v90
    v_cmp_eq_u32 s[40:41], 3, v90
    v_fmamk_f32 v212, v88, 0x0, v89
    v_fmamk_f32 v213, v88, 0x43000000, v89
    v_fmamk_f32 v214, v88, 0x43800000, v89
    v_fmamk_f32 v215, v88, 0x43c00000, v89
    v_fmamk_f32 v216, v88, 0x44000000, v89
    v_mov_b32 v119, 0
    v_mov_b32 v135, 0
    v_sin_f32 v218, v212
    v_sin_f32 v219, v213
    v_sin_f32 v220, v214
    v_sin_f32 v221, v215
    v_sin_f32 v222, v216
    v_cos_f32 v212, v212
    v_cos_f32 v213, v213
    v_cos_f32 v214, v214
    v_cos_f32 v215, v215
    v_cos_f32 v216, v216
    v_cvt_pk_bf16_f32 v132, v218, v219
    v_cvt_pk_bf16_f32 v133, v220, v221
    v_cvt_pk_bf16_f32 v134, v222, 0
    v_cvt_pk_bf16_f32 v116, v212, v213
    v_cvt_pk_bf16_f32 v117, v214, v215
    v_cvt_pk_bf16_f32 v118, v216, 0
    ds_write_b128 v87, v[116:119] offset:28672
    ds_write_b128 v87, v[132:135] offset:29696
    v_mov_b32 v151, 0
    v_mov_b32 v155, 0
    v_mov_b32 v159, 0
    v_mov_b32 v167, 0
    v_mov_b32 v171, 0
    v_mov_b32 v175, 0
    v_lshrrev_b32 v87, 2, v84
    v_mul_u32_u24 v224, 160, v87
    v_and_b32 v87, 3, v84
    v_lshl_add_u32 v224, v87, 3, v224
    v_lshlrev_b32 v225, 3, v85
    v_mov_b32 v226, 0
    v_mov_b32 v227, 0
    v_mov_b32 v228, 0
    v_mov_b32 v229, 0
    v_mov_b32 v230, 0
    v_mov_b32 v231, 0
    v_mov_b32 v232, 0
    v_mov_b32 v233, 0
    s_mov_b32 s24, 81600
    v_lshlrev_b32 v215, 4, v84
    v_add_u32 v87, 0, v84
    v_mul_u32_u24 v88, 3277, v87
    v_lshrrev_b32 v88, 16, v88
    v_lshlrev_b32 v87, 4, v87
    v_mad_u32_u24 v212, v88, s24, v87
    v_add_u32 v87, 64, v84
    v_mul_u32_u24 v88, 3277, v87
    v_lshrrev_b32 v88, 16, v88
    v_lshlrev_b32 v87, 4, v87
    v_mad_u32_u24 v213, v88, s24, v87
    v_add_u32 v87, 128, v84
    v_mul_u32_u24 v88, 3277, v87
    v_lshrrev_b32 v88, 16, v88
    v_lshlrev_b32 v87, 4, v87
    v_mad_u32_u24 v214, v88, s24, v87
    v_add_u32 v215, s62, v215
    s_mov_b32 s24, 0x3f803f80
    s_waitcnt vmcnt(19)
    v_dot2c_f32_bf16 v226, s24, v2
    v_dot2c_f32_bf16 v228, v2, v2
    v_dot2c_f32_bf16 v227, s24, v3
    v_dot2c_f32_bf16 v229, v3, v3
    v_dot2c_f32_bf16 v226, s24, v4
    v_dot2c_f32_bf16 v228, v4, v4
    v_dot2c_f32_bf16 v227, s24, v5
    v_dot2c_f32_bf16 v229, v5, v5
    s_waitcnt vmcnt(18)
    v_dot2c_f32_bf16 v226, s24, v6
    v_dot2c_f32_bf16 v228, v6, v6
    v_dot2c_f32_bf16 v227, s24, v7
    v_dot2c_f32_bf16 v229, v7, v7
    v_dot2c_f32_bf16 v226, s24, v8
    v_dot2c_f32_bf16 v228, v8, v8
    v_dot2c_f32_bf16 v227, s24, v9
    v_dot2c_f32_bf16 v229, v9, v9
    s_waitcnt vmcnt(17)
    v_dot2c_f32_bf16 v226, s24, v10
    v_dot2c_f32_bf16 v228, v10, v10
    v_dot2c_f32_bf16 v227, s24, v11
    v_dot2c_f32_bf16 v229, v11, v11
    v_dot2c_f32_bf16 v226, s24, v12
    v_dot2c_f32_bf16 v228, v12, v12
    v_dot2c_f32_bf16 v227, s24, v13
    v_dot2c_f32_bf16 v229, v13, v13
    s_waitcnt vmcnt(16)
    v_dot2c_f32_bf16 v226, s24, v14
    v_dot2c_f32_bf16 v228, v14, v14
    v_dot2c_f32_bf16 v227, s24, v15
    v_dot2c_f32_bf16 v229, v15, v15
    v_dot2c_f32_bf16 v226, s24, v16
    v_dot2c_f32_bf16 v228, v16, v16
    v_dot2c_f32_bf16 v227, s24, v17
    v_dot2c_f32_bf16 v229, v17, v17
    s_waitcnt vmcnt(15)
    v_dot2c_f32_bf16 v226, s24, v18
    v_dot2c_f32_bf16 v228, v18, v18
    v_dot2c_f32_bf16 v227, s24, v19
    v_dot2c_f32_bf16 v229, v19, v19
    v_dot2c_f32_bf16 v226, s24, v20
    v_dot2c_f32_bf16 v228, v20, v20
    v_dot2c_f32_bf16 v227, s24, v21
    v_dot2c_f32_bf16 v229, v21, v21
    s_waitcnt vmcnt(14)
    v_dot2c_f32_bf16 v226, s24, v22
    v_dot2c_f32_bf16 v228, v22, v22
    v_dot2c_f32_bf16 v227, s24, v23
    v_dot2c_f32_bf16 v229, v23, v23
    v_dot2c_f32_bf16 v226, s24, v24
    v_dot2c_f32_bf16 v228, v24, v24
    v_dot2c_f32_bf16 v227, s24, v25
    v_dot2c_f32_bf16 v229, v25, v25
    s_waitcnt vmcnt(13)
    v_dot2c_f32_bf16 v226, s24, v26
    v_dot2c_f32_bf16 v228, v26, v26
    v_dot2c_f32_bf16 v227, s24, v27
    v_dot2c_f32_bf16 v229, v27, v27
    v_dot2c_f32_bf16 v226, s24, v28
    v_dot2c_f32_bf16 v228, v28, v28
    v_dot2c_f32_bf16 v227, s24, v29
    v_dot2c_f32_bf16 v229, v29, v29
    s_waitcnt vmcnt(12)
    v_dot2c_f32_bf16 v226, s24, v30
    v_dot2c_f32_bf16 v228, v30, v30
    v_dot2c_f32_bf16 v227, s24, v31
    v_dot2c_f32_bf16 v229, v31, v31
    v_dot2c_f32_bf16 v226, s24, v32
    v_dot2c_f32_bf16 v228, v32, v32
    v_dot2c_f32_bf16 v227, s24, v33
    v_dot2c_f32_bf16 v229, v33, v33
    s_waitcnt vmcnt(11)
    v_dot2c_f32_bf16 v226, s24, v34
    v_dot2c_f32_bf16 v228, v34, v34
    v_dot2c_f32_bf16 v227, s24, v35
    v_dot2c_f32_bf16 v229, v35, v35
    v_dot2c_f32_bf16 v226, s24, v36
    v_dot2c_f32_bf16 v228, v36, v36
    v_dot2c_f32_bf16 v227, s24, v37
    v_dot2c_f32_bf16 v229, v37, v37
    s_waitcnt vmcnt(10)
    v_dot2c_f32_bf16 v226, s24, v38
    v_dot2c_f32_bf16 v228, v38, v38
    v_dot2c_f32_bf16 v227, s24, v39
    v_dot2c_f32_bf16 v229, v39, v39
    v_dot2c_f32_bf16 v226, s24, v40
    v_dot2c_f32_bf16 v228, v40, v40
    v_dot2c_f32_bf16 v227, s24, v41
    v_dot2c_f32_bf16 v229, v41, v41
    s_mov_b64 exec, s[28:29]
    s_bitcmp1_b32 s21, 0
    s_cbranch_scc1 A_odd0
    ds_write_b64 v83, v[2:3] offset:0
    ds_write_b64 v83, v[6:7] offset:16
    ds_write_b64 v83, v[10:11] offset:32
    ds_write_b64 v83, v[14:15] offset:48
    ds_write_b64 v83, v[18:19] offset:64
    ds_write_b64 v83, v[22:23] offset:80
    ds_write_b64 v83, v[26:27] offset:96
    ds_write_b64 v83, v[30:31] offset:112
    ds_write_b64 v83, v[34:35] offset:128
    ds_write_b64 v83, v[38:39] offset:144
    s_branch A_done0
A_odd0:
    ds_write_b64 v83, v[4:5] offset:0
    ds_write_b64 v83, v[8:9] offset:16
    ds_write_b64 v83, v[12:13] offset:32
    ds_write_b64 v83, v[16:17] offset:48
    ds_write_b64 v83, v[20:21] offset:64
    ds_write_b64 v83, v[24:25] offset:80
    ds_write_b64 v83, v[28:29] offset:96
    ds_write_b64 v83, v[32:33] offset:112
    ds_write_b64 v83, v[36:37] offset:128
    ds_write_b64 v83, v[40:41] offset:144
A_done0:
    s_mov_b64 exec, -1
    s_waitcnt vmcnt(9)
    v_dot2c_f32_bf16 v230, s24, v42
    v_dot2c_f32_bf16 v232, v42, v42
    v_dot2c_f32_bf16 v231, s24, v43
    v_dot2c_f32_bf16 v233, v43, v43
    v_dot2c_f32_bf16 v230, s24, v44
    v_dot2c_f32_bf16 v232, v44, v44
    v_dot2c_f32_bf16 v231, s24, v45
    v_dot2c_f32_bf16 v233, v45, v45
    s_waitcnt vmcnt(8)
    v_dot2c_f32_bf16 v230, s24, v46
    v_dot2c_f32_bf16 v232, v46, v46
    v_dot2c_f32_bf16 v231, s24, v47
    v_dot2c_f32_bf16 v233, v47, v47
    v_dot2c_f32_bf16 v230, s24, v48
    v_dot2c_f32_bf16 v232, v48, v48
    v_dot2c_f32_bf16 v231, s24, v49
    v_dot2c_f32_bf16 v233, v49, v49
    s_waitcnt vmcnt(7)
    v_dot2c_f32_bf16 v230, s24, v50
    v_dot2c_f32_bf16 v232, v50, v50
    v_dot2c_f32_bf16 v231, s24, v51
    v_dot2c_f32_bf16 v233, v51, v51
    v_dot2c_f32_bf16 v230, s24, v52
    v_dot2c_f32_bf16 v232, v52, v52
    v_dot2c_f32_bf16 v231, s24, v53
    v_dot2c_f32_bf16 v233, v53, v53
    s_waitcnt vmcnt(6)
    v_dot2c_f32_bf16 v230, s24, v54
    v_dot2c_f32_bf16 v232, v54, v54
    v_dot2c_f32_bf16 v231, s24, v55
    v_dot2c_f32_bf16 v233, v55, v55
    v_dot2c_f32_bf16 v230, s24, v56
    v_dot2c_f32_bf16 v232, v56, v56
    v_dot2c_f32_bf16 v231, s24, v57
    v_dot2c_f32_bf16 v233, v57, v57
    s_waitcnt vmcnt(5)
    v_dot2c_f32_bf16 v230, s24, v58
    v_dot2c_f32_bf16 v232, v58, v58
    v_dot2c_f32_bf16 v231, s24, v59
    v_dot2c_f32_bf16 v233, v59, v59
    v_dot2c_f32_bf16 v230, s24, v60
    v_dot2c_f32_bf16 v232, v60, v60
    v_dot2c_f32_bf16 v231, s24, v61
    v_dot2c_f32_bf16 v233, v61, v61
    s_waitcnt vmcnt(4)
    v_dot2c_f32_bf16 v230, s24, v62
    v_dot2c_f32_bf16 v232, v62, v62
    v_dot2c_f32_bf16 v231, s24, v63
    v_dot2c_f32_bf16 v233, v63, v63
    v_dot2c_f32_bf16 v230, s24, v64
    v_dot2c_f32_bf16 v232, v64, v64
    v_dot2c_f32_bf16 v231, s24, v65
    v_dot2c_f32_bf16 v233, v65, v65
    s_waitcnt vmcnt(3)
    v_dot2c_f32_bf16 v230, s24, v66
    v_dot2c_f32_bf16 v232, v66, v66
    v_dot2c_f32_bf16 v231, s24, v67
    v_dot2c_f32_bf16 v233, v67, v67
    v_dot2c_f32_bf16 v230, s24, v68
    v_dot2c_f32_bf16 v232, v68, v68
    v_dot2c_f32_bf16 v231, s24, v69
    v_dot2c_f32_bf16 v233, v69, v69
    s_waitcnt vmcnt(2)
    v_dot2c_f32_bf16 v230, s24, v70
    v_dot2c_f32_bf16 v232, v70, v70
    v_dot2c_f32_bf16 v231, s24, v71
    v_dot2c_f32_bf16 v233, v71, v71
    v_dot2c_f32_bf16 v230, s24, v72
    v_dot2c_f32_bf16 v232, v72, v72
    v_dot2c_f32_bf16 v231, s24, v73
    v_dot2c_f32_bf16 v233, v73, v73
    s_waitcnt vmcnt(1)
    v_dot2c_f32_bf16 v230, s24, v74
    v_dot2c_f32_bf16 v232, v74, v74
    v_dot2c_f32_bf16 v231, s24, v75
    v_dot2c_f32_bf16 v233, v75, v75
    v_dot2c_f32_bf16 v230, s24, v76
    v_dot2c_f32_bf16 v232, v76, v76
    v_dot2c_f32_bf16 v231, s24, v77
    v_dot2c_f32_bf16 v233, v77, v77
    s_waitcnt vmcnt(0)
    v_dot2c_f32_bf16 v230, s24, v78
    v_dot2c_f32_bf16 v232, v78, v78
    v_dot2c_f32_bf16 v231, s24, v79
    v_dot2c_f32_bf16 v233, v79, v79
    v_dot2c_f32_bf16 v230, s24, v80
    v_dot2c_f32_bf16 v232, v80, v80
    v_dot2c_f32_bf16 v231, s24, v81
    v_dot2c_f32_bf16 v233, v81, v81
    s_mov_b64 exec, s[28:29]
    s_bitcmp1_b32 s21, 0
    s_cbranch_scc1 A_odd1
    ds_write_b64 v83, v[42:43] offset:1280
    ds_write_b64 v83, v[46:47] offset:1296
    ds_write_b64 v83, v[50:51] offset:1312
    ds_write_b64 v83, v[54:55] offset:1328
    ds_write_b64 v83, v[58:59] offset:1344
    ds_write_b64 v83, v[62:63] offset:1360
    ds_write_b64 v83, v[66:67] offset:1376
    ds_write_b64 v83, v[70:71] offset:1392
    ds_write_b64 v83, v[74:75] offset:1408
    ds_write_b64 v83, v[78:79] offset:1424
    s_branch A_done1
A_odd1:
    ds_write_b64 v83, v[44:45] offset:1280
    ds_write_b64 v83, v[48:49] offset:1296
    ds_write_b64 v83, v[52:53] offset:1312
    ds_write_b64 v83, v[56:57] offset:1328
    ds_write_b64 v83, v[60:61] offset:1344
    ds_write_b64 v83, v[64:65] offset:1360
    ds_write_b64 v83, v[68:69] offset:1376
    ds_write_b64 v83, v[72:73] offset:1392
    ds_write_b64 v83, v[76:77] offset:1408
    ds_write_b64 v83, v[80:81] offset:1424
A_done1:
    s_mov_b64 exec, -1
    s_nop 1
    v_add_f32 v226, v226, v227
    v_add_f32 v228, v228, v229
    v_add_f32 v230, v230, v231
    v_add_f32 v232, v232, v233
    v_add_f32_dpp v226, v226, v226 quad_perm:[1,0,3,2] row_mask:0xf bank_mask:0xf
    v_add_f32_dpp v228, v228, v228 quad_perm:[1,0,3,2] row_mask:0xf bank_mask:0xf
    v_add_f32_dpp v230, v230, v230 quad_perm:[1,0,3,2] row_mask:0xf bank_mask:0xf
    v_add_f32_dpp v232, v232, v232 quad_perm:[1,0,3,2] row_mask:0xf bank_mask:0xf
    v_add_f32_dpp v226, v226, v226 quad_perm:[2,3,0,1] row_mask:0xf bank_mask:0xf
    v_add_f32_dpp v228, v228, v228 quad_perm:[2,3,0,1] row_mask:0xf bank_mask:0xf
    v_add_f32_dpp v230, v230, v230 quad_perm:[2,3,0,1] row_mask:0xf bank_mask:0xf
    v_add_f32_dpp v232, v232, v232 quad_perm:[2,3,0,1] row_mask:0xf bank_mask:0xf
    v_add_f32_dpp v226, v226, v226 row_half_mirror row_mask:0xf bank_mask:0xf
    v_add_f32_dpp v228, v228, v228 row_half_mirror row_mask:0xf bank_mask:0xf
    v_add_f32_dpp v230, v230, v230 row_half_mirror row_mask:0xf bank_mask:0xf
    v_add_f32_dpp v232, v232, v232 row_half_mirror row_mask:0xf bank_mask:0xf
    v_cndmask_b32_e64 v87, v226, v230, s[32:33]
    v_cndmask_b32_e64 v88, v228, v232, s[32:33]
    v_mul_f32 v87, 0xbacccccd, v87
    v_mul_f32 v88, 0x3acccccd, v88
    v_fma_f32 v88, -v87, v87, v88
    v_max_f32 v88, 0, v88
    v_cvt_pk_bf16_f32 v90, v87, v87
    v_cvt_pk_bf16_f32 v89, v88, v88
    v_lshlrev_b32 v88, 16, v89
    ds_write_b16 v96, v90 offset:10496
    v_add_f32 v88, 0x3727c5ac, v88
    v_cvt_pk_bf16_f32 v89, v88, v88
    v_lshlrev_b32 v88, 16, v89
    v_sqrt_f32 v88, v88
    s_nop 0
    v_cvt_pk_bf16_f32 v89, v88, v88
    v_lshlrev_b32 v88, 16, v89
    v_rcp_f32 v88, v88
    s_nop 0
    ds_write_b32 v95, v88 offset:10240
    s_waitcnt lgkmcnt(0)
    s_barrier
    v_lshlrev_b32 v87, 1, v225
    ds_read_b128 v[2:5], v87 offset:10240
    ds_read_b128 v[6:9], v87 offset:10304
    ds_read_b128 v[10:13], v87 offset:10368
    ds_read_b128 v[14:17], v87 offset:10432
    ds_read_b64 v[18:19], v225 offset:10496
    ds_read_b64 v[20:21], v225 offset:10528
    ds_read_b64 v[22:23], v225 offset:10560
    ds_read_b64 v[24:25], v225 offset:10592
    ds_read_b64_tr_b16 v[26:27], v224 offset:0
    ds_read_b64_tr_b16 v[28:29], v224 offset:2560
    ds_read_b64_tr_b16 v[30:31], v224 offset:32
    ds_read_b64_tr_b16 v[32:33], v224 offset:2592
    ds_read_b64_tr_b16 v[34:35], v224 offset:64
    ds_read_b64_tr_b16 v[36:37], v224 offset:2624
    ds_read_b64_tr_b16 v[38:39], v224 offset:96
    ds_read_b64_tr_b16 v[40:41], v224 offset:2656
    ds_read_b64_tr_b16 v[42:43], v224 offset:128
    ds_read_b64_tr_b16 v[44:45], v224 offset:2688
    ds_read_b64_tr_b16 v[46:47], v224 offset:5120
    ds_read_b64_tr_b16 v[48:49], v224 offset:7680
    ds_read_b64_tr_b16 v[50:51], v224 offset:5152
    ds_read_b64_tr_b16 v[52:53], v224 offset:7712
    ds_read_b64_tr_b16 v[54:55], v224 offset:5184
    ds_read_b64_tr_b16 v[56:57], v224 offset:7744
    ds_read_b64_tr_b16 v[58:59], v224 offset:5216
    ds_read_b64_tr_b16 v[60:61], v224 offset:7776
    ds_read_b64_tr_b16 v[62:63], v224 offset:5248
    ds_read_b64_tr_b16 v[64:65], v224 offset:7808
    s_waitcnt lgkmcnt(15)
    v_mul_f32 v98, v98, v2
    v_mul_f32 v99, v99, v3
    v_mul_f32 v100, v100, v4
    v_mul_f32 v101, v101, v5
    v_mul_f32 v102, v102, v6
    v_mul_f32 v103, v103, v7
    v_mul_f32 v104, v104, v8
    v_mul_f32 v105, v105, v9
    v_mul_f32 v106, v106, v10
    v_mul_f32 v107, v107, v11
    v_mul_f32 v108, v108, v12
    v_mul_f32 v109, v109, v13
    v_mul_f32 v110, v110, v14
    v_mul_f32 v111, v111, v15
    v_mul_f32 v112, v112, v16
    v_mul_f32 v113, v113, v17
    v_cvt_pk_bf16_f32 v98, v98, v99
    v_cvt_pk_bf16_f32 v99, v100, v101
    v_cvt_pk_bf16_f32 v100, v102, v103
    v_cvt_pk_bf16_f32 v101, v104, v105
    v_cvt_pk_bf16_f32 v102, v106, v107
    v_cvt_pk_bf16_f32 v103, v108, v109
    v_cvt_pk_bf16_f32 v104, v110, v111
    v_cvt_pk_bf16_f32 v105, v112, v113
    v_mfma_f32_16x16x32_bf16 v[66:69], v[18:21], v[98:101], 0
    s_nop 0
    v_mfma_f32_16x16x32_bf16 v[66:69], v[22:25], v[102:105], v[66:69]
    s_waitcnt lgkmcnt(10)
    v_mfma_f32_16x16x32_bf16 v[234:237], v[26:29], v[98:101], v[66:69]
    v_mfma_f32_16x16x32_bf16 v[238:241], v[30:33], v[98:101], v[66:69]
    v_mfma_f32_16x16x32_bf16 v[242:245], v[34:37], v[98:101], v[66:69]
    v_mfma_f32_16x16x32_bf16 v[246:249], v[38:41], v[98:101], v[66:69]
    v_mfma_f32_16x16x32_bf16 v[250:253], v[42:45], v[98:101], v[66:69]
    s_waitcnt lgkmcnt(0)
    ds_read_b128 v[160:163], v223 offset:36864
    ds_read_b128 v[176:179], v223 offset:37888
    ds_read_b128 v[116:119], v223 offset:28672
    ds_read_b128 v[132:135], v223 offset:29696
    ds_read_b128 v[120:123], v223 offset:30720
    ds_read_b128 v[136:139], v223 offset:31744
    ds_read_b128 v[124:127], v223 offset:32768
    ds_read_b128 v[140:143], v223 offset:33792
    ds_read_b128 v[128:131], v223 offset:34816
    ds_read_b128 v[144:147], v223 offset:35840
    v_mfma_f32_16x16x32_bf16 v[234:237], v[46:49], v[102:105], v[234:237]
    v_mfma_f32_16x16x32_bf16 v[238:241], v[50:53], v[102:105], v[238:241]
    v_mfma_f32_16x16x32_bf16 v[242:245], v[54:57], v[102:105], v[242:245]
    v_mfma_f32_16x16x32_bf16 v[246:249], v[58:61], v[102:105], v[246:249]
    v_mfma_f32_16x16x32_bf16 v[250:253], v[62:65], v[102:105], v[250:253]
    s_waitcnt lgkmcnt(8)
    v_cndmask_b32_e64 v148, 0, v160, s[34:35]
    v_cndmask_b32_e64 v149, 0, v161, s[34:35]
    v_cndmask_b32_e64 v150, 0, v162, s[34:35]
    v_cndmask_b32_e64 v164, 0, v176, s[34:35]
    v_cndmask_b32_e64 v165, 0, v177, s[34:35]
    v_cndmask_b32_e64 v166, 0, v178, s[34:35]
    v_cndmask_b32_e64 v152, 0, v160, s[36:37]
    v_cndmask_b32_e64 v153, 0, v161, s[36:37]
    v_cndmask_b32_e64 v154, 0, v162, s[36:37]
    v_cndmask_b32_e64 v168, 0, v176, s[36:37]
    v_cndmask_b32_e64 v169, 0, v177, s[36:37]
    v_cndmask_b32_e64 v170, 0, v178, s[36:37]
    v_cndmask_b32_e64 v156, 0, v160, s[38:39]
    v_cndmask_b32_e64 v157, 0, v161, s[38:39]
    v_cndmask_b32_e64 v158, 0, v162, s[38:39]
    v_cndmask_b32_e64 v172, 0, v176, s[38:39]
    v_cndmask_b32_e64 v173, 0, v177, s[38:39]
    v_cndmask_b32_e64 v174, 0, v178, s[38:39]
    v_cndmask_b32_e64 v160, 0, v160, s[40:41]
    v_cndmask_b32_e64 v161, 0, v161, s[40:41]
    v_cndmask_b32_e64 v162, 0, v162, s[40:41]
    v_cndmask_b32_e64 v176, 0, v176, s[40:41]
    v_cndmask_b32_e64 v177, 0, v177, s[40:41]
    v_cndmask_b32_e64 v178, 0, v178, s[40:41]
    v_cvt_pk_bf16_f32 v180, v234, v238
    v_cvt_pk_bf16_f32 v181, v242, v246
    v_cvt_pk_bf16_f32 v182, v250, 0
    v_cvt_pk_bf16_f32 v184, v235, v239
    v_cvt_pk_bf16_f32 v185, v243, v247
    v_cvt_pk_bf16_f32 v186, v251, 0
    v_cvt_pk_bf16_f32 v188, v236, v240
    v_cvt_pk_bf16_f32 v189, v244, v248
    v_cvt_pk_bf16_f32 v190, v252, 0
    v_cvt_pk_bf16_f32 v192, v237, v241
    v_cvt_pk_bf16_f32 v193, v245, v249
    v_cvt_pk_bf16_f32 v194, v253, 0
    v_xor_b32_dpp v196, v180, v114 row_ror:8 row_mask:0xf bank_mask:0xf
    v_xor_b32_dpp v197, v181, v114 row_ror:8 row_mask:0xf bank_mask:0xf
    v_xor_b32_dpp v198, v182, v114 row_ror:8 row_mask:0xf bank_mask:0xf
    v_xor_b32_dpp v200, v184, v114 row_ror:8 row_mask:0xf bank_mask:0xf
    v_xor_b32_dpp v201, v185, v114 row_ror:8 row_mask:0xf bank_mask:0xf
    v_xor_b32_dpp v202, v186, v114 row_ror:8 row_mask:0xf bank_mask:0xf
    v_xor_b32_dpp v204, v188, v114 row_ror:8 row_mask:0xf bank_mask:0xf
    v_xor_b32_dpp v205, v189, v114 row_ror:8 row_mask:0xf bank_mask:0xf
    v_xor_b32_dpp v206, v190, v114 row_ror:8 row_mask:0xf bank_mask:0xf
    v_xor_b32_dpp v208, v192, v114 row_ror:8 row_mask:0xf bank_mask:0xf
    v_xor_b32_dpp v209, v193, v114 row_ror:8 row_mask:0xf bank_mask:0xf
    v_xor_b32_dpp v210, v194, v114 row_ror:8 row_mask:0xf bank_mask:0xf
    s_waitcnt lgkmcnt(0)
    v_mfma_f32_16x16x32_bf16 v[2:5], v[116:119], v[180:183], 0
    v_mfma_f32_16x16x32_bf16 v[6:9], v[120:123], v[184:187], 0
    v_mfma_f32_16x16x32_bf16 v[10:13], v[124:127], v[188:191], 0
    v_mfma_f32_16x16x32_bf16 v[14:17], v[128:131], v[192:195], 0
    v_mfma_f32_16x16x32_bf16 v[2:5], v[132:135], v[196:199], v[2:5]
    v_mfma_f32_16x16x32_bf16 v[6:9], v[136:139], v[200:203], v[6:9]
    v_mfma_f32_16x16x32_bf16 v[10:13], v[140:143], v[204:207], v[10:13]
    v_mfma_f32_16x16x32_bf16 v[14:17], v[144:147], v[208:211], v[14:17]
    v_mfma_f32_16x16x32_bf16 v[18:21], v[148:151], v[180:183], 0
    v_mfma_f32_16x16x32_bf16 v[18:21], v[164:167], v[196:199], v[18:21]
    v_mfma_f32_16x16x32_bf16 v[18:21], v[152:155], v[184:187], v[18:21]
    v_mfma_f32_16x16x32_bf16 v[18:21], v[168:171], v[200:203], v[18:21]
    v_mfma_f32_16x16x32_bf16 v[18:21], v[156:159], v[188:191], v[18:21]
    v_mfma_f32_16x16x32_bf16 v[18:21], v[172:175], v[204:207], v[18:21]
    v_mfma_f32_16x16x32_bf16 v[18:21], v[160:163], v[192:195], v[18:21]
    v_mfma_f32_16x16x32_bf16 v[18:21], v[176:179], v[208:211], v[18:21]
    v_cvt_pk_bf16_f32 v22, v2, v6
    v_cvt_pk_bf16_f32 v23, v10, v14
    ds_write_b64 v115, v[22:23] offset:0
    v_cvt_pk_bf16_f32 v24, v3, v7
    v_cvt_pk_bf16_f32 v25, v11, v15
    ds_write_b64 v115, v[24:25] offset:8
    v_cvt_pk_bf16_f32 v26, v4, v8
    v_cvt_pk_bf16_f32 v27, v12, v16
    ds_write_b64 v115, v[26:27] offset:16
    v_cvt_pk_bf16_f32 v28, v5, v9
    v_cvt_pk_bf16_f32 v29, v13, v17
    ds_write_b64 v115, v[28:29] offset:24
    v_cvt_pk_bf16_f32 v30, v18, v19
    v_cvt_pk_bf16_f32 v31, v20, v21
    ds_write_b64 v115, v[30:31] offset:32
    s_waitcnt lgkmcnt(0)
    ds_read_b128 v[34:37], v215 offset:0
    ds_read_b128 v[38:41], v215 offset:1024
    ds_read_b128 v[42:45], v215 offset:2048
    s_waitcnt lgkmcnt(2)
    buffer_store_dwordx4 v[34:37], v212, s[12:15], s63 offen sc1
    s_waitcnt lgkmcnt(1)
    buffer_store_dwordx4 v[38:41], v213, s[12:15], s63 offen sc1
    s_waitcnt lgkmcnt(0)
    s_mov_b32 exec_hi, 0
    buffer_store_dwordx4 v[42:45], v214, s[12:15], s63 offen sc1
    s_mov_b32 exec_hi, -1
    v_and_b32 v4, 63, v0
    v_lshrrev_b32 v5, 4, v4
    v_and_b32 v6, 15, v4
    v_and_b32 v7, 7, v4
    v_lshrrev_b32 v8, 5, v4
    s_lshl_b32 s24, s21, 2
    s_cmp_eq_u32 s20, 0
    s_cbranch_scc1 B_special
    v_add_u32 v15, s24, v7
    v_lshlrev_b32 v15, 6, v15
    v_mov_b32 v16, 0
    v_cmp_gt_u32 vcc, 4, v7
    s_nop 1
    v_cndmask_b32_e64 v17, 0, 1.0, vcc
    s_add_u32 s25, s24, s22
    s_lshl_b32 s25, s25, 6
    s_add_u32 s25, s25, s20
    s_sub_u32 s26, 2048, s25
    v_cmp_eq_u32 vcc, 0, v8
    v_mov_b32 v9, s26
    v_mov_b32 v10, s25
    v_mov_b32 v11, s22
    v_cndmask_b32 v18, v9, v10, vcc
    v_cndmask_b32_e64 v19, 4, v11, vcc
    v_cndmask_b32_e64 v20, v11, 4, vcc
    s_branch B_common
B_special:
    v_lshrrev_b32 v9, 1, v7
    v_add_u32 v9, s24, v9
    v_sub_u32 v10, 64, v9
    v_and_b32 v15, 1, v7
    v_cmp_eq_u32 vcc, 1, v15
    s_nop 1
    v_cndmask_b32 v15, v9, v10, vcc
    v_cmp_eq_u32 vcc, 64, v15
    s_nop 1
    v_cndmask_b32_e64 v15, v15, 32, vcc
    v_and_b32 v16, 1, v15
    v_lshlrev_b32 v16, 9, v16
    v_lshlrev_b32 v15, 5, v15
    v_mov_b32 v17, 0.5
    s_lshl_b32 s25, s22, 1
    v_add_u32 v19, s25, v8
    v_lshrrev_b32 v9, 1, v19
    v_add_u32 v9, s24, v9
    v_sub_u32 v10, 64, v9
    v_and_b32 v18, 1, v19
    v_cmp_eq_u32 vcc, 1, v18
    s_nop 1
    v_cndmask_b32 v18, v9, v10, vcc
    v_cmp_eq_u32 vcc, 64, v18
    s_nop 1
    v_cndmask_b32_e64 v18, v18, 32, vcc
    v_and_b32 v9, 31, v18
    v_xor_b32 v10, 1, v19
    v_cmp_eq_u32 vcc, 0, v9
    s_nop 1
    v_cndmask_b32 v20, v10, v19, vcc
    v_lshlrev_b32 v18, 5, v18
B_common:
    v_and_b32 v43, 31, v4
    v_mul_u32_u24 v9, 40, v43
    v_lshrrev_b32 v10, 5, v0
    v_lshlrev_b32 v10, 7, v10
    v_add_u32 v10, 103040, v10
    v_add_u32 v42, 113280, v9
    v_add_u32 v11, 0, v9
    v_lshrrev_b32 v12, 7, v11
    v_mul_u32_u24 v12, 896, v12
    v_add3_u32 v22, v10, v11, v12
    v_add_u32 v11, 8, v9
    v_lshrrev_b32 v12, 7, v11
    v_mul_u32_u24 v12, 896, v12
    v_add3_u32 v24, v10, v11, v12
    v_add_u32 v11, 16, v9
    v_lshrrev_b32 v12, 7, v11
    v_mul_u32_u24 v12, 896, v12
    v_add3_u32 v26, v10, v11, v12
    v_add_u32 v11, 24, v9
    v_lshrrev_b32 v12, 7, v11
    v_mul_u32_u24 v12, 896, v12
    v_add3_u32 v28, v10, v11, v12
    v_add_u32 v11, 32, v9
    v_lshrrev_b32 v12, 7, v11
    v_mul_u32_u24 v12, 896, v12
    v_add3_u32 v30, v10, v11, v12
    s_waitcnt vmcnt(0)
    s_barrier
    ds_read_b64 v[22:23], v22
    ds_read_b64 v[32:33], v42 offset:0
    ds_read_b64 v[24:25], v24
    ds_read_b64 v[34:35], v42 offset:8
    ds_read_b64 v[26:27], v26
    ds_read_b64 v[36:37], v42 offset:16
    ds_read_b64 v[28:29], v28
    ds_read_b64 v[38:39], v42 offset:24
    ds_read_b64 v[30:31], v30
    ds_read_b64 v[40:41], v42 offset:32
    v_and_b32 v7, 1, v5
    v_lshrrev_b32 v8, 1, v5
    v_lshlrev_b32 v7, 2, v7
    v_lshl_add_u32 v7, v8, 4, v7
    v_lshrrev_b32 v8, 3, v6
    v_lshl_add_u32 v9, v8, 9, v16
    v_mad_u32_u24 v9, v15, v7, v9
    v_cvt_f32_u32 v10, v15
    v_cvt_f32_u32 v9, v9
    v_mul_f32 v10, 0x3a000000, v10
    v_mul_f32 v9, 0x3a000000, v9
    v_bfe_u32 v11, v4, 2, 2
    v_add_u32 v11, v11, v7
    v_mul_u32_u24 v76, 2568, v11
    v_and_b32 v11, 3, v4
    v_mul_u32_u24 v11, 320, v11
    s_mul_i32 s24, s22, 40
    v_add3_u32 v76, v76, v11, s24
    v_and_b32 v11, 7, v4
    v_mul_u32_u24 v11, 2576, v11
    v_lshl_add_u32 v11, v8, 6, v11
    v_lshl_add_u32 v11, v5, 4, v11
    s_lshl_b32 s24, s22, 9
    s_add_u32 s24, s24, 82432
    v_add_u32 v77, s24, v11
    s_lshl_b32 s24, s22, 7
    s_add_u32 s24, s24, 84480
    v_add_u32 v78, s24, v11
    v_bfrev_b32 v79, 1
    v_fmamk_f32 v60, v10, 0x0, v9
    v_fmamk_f32 v61, v10, 0x3f800000, v9
    v_fmamk_f32 v62, v10, 0x40000000, v9
    v_fmamk_f32 v63, v10, 0x40400000, v9
    v_fmamk_f32 v64, v10, 0x41000000, v9
    v_fmamk_f32 v65, v10, 0x41100000, v9
    v_fmamk_f32 v66, v10, 0x41200000, v9
    v_fmamk_f32 v67, v10, 0x41300000, v9
    v_sin_f32 v68, v60
    v_sin_f32 v69, v61
    v_sin_f32 v70, v62
    v_sin_f32 v71, v63
    v_sin_f32 v72, v64
    v_sin_f32 v73, v65
    v_sin_f32 v74, v66
    v_sin_f32 v75, v67
    v_cos_f32 v60, v60
    v_cos_f32 v61, v61
    v_cos_f32 v62, v62
    v_cos_f32 v63, v63
    v_cos_f32 v64, v64
    v_cos_f32 v65, v65
    v_cos_f32 v66, v66
    v_cos_f32 v67, v67
    v_mul_f32 v68, v17, v68
    v_mul_f32 v69, v17, v69
    v_mul_f32 v70, v17, v70
    v_mul_f32 v71, v17, v71
    v_mul_f32 v72, v17, v72
    v_mul_f32 v73, v17, v73
    v_mul_f32 v74, v17, v74
    v_mul_f32 v75, v17, v75
    v_mul_f32 v60, v17, v60
    v_mul_f32 v61, v17, v61
    v_mul_f32 v62, v17, v62
    v_mul_f32 v63, v17, v63
    v_mul_f32 v64, v17, v64
    v_mul_f32 v65, v17, v65
    v_mul_f32 v66, v17, v66
    v_mul_f32 v67, v17, v67
    v_cvt_pk_bf16_f32 v48, v68, v69
    v_cvt_pk_bf16_f32 v49, v70, v71
    v_cvt_pk_bf16_f32 v50, v72, v73
    v_cvt_pk_bf16_f32 v51, v74, v75
    v_cvt_pk_bf16_f32 v44, v60, v61
    v_cvt_pk_bf16_f32 v45, v62, v63
    v_cvt_pk_bf16_f32 v46, v64, v65
    v_cvt_pk_bf16_f32 v47, v66, v67
    v_cvt_f32_u32 v10, v6
    v_cvt_f32_u32 v9, v5
    v_mul_f32 v10, 0x3d000000, v10
    v_mul_f32 v9, 4.0, v9
    v_mul_f32 v9, v10, v9
    v_fmamk_f32 v60, v10, 0x0, v9
    v_fmamk_f32 v61, v10, 0x3f800000, v9
    v_fmamk_f32 v62, v10, 0x40000000, v9
    v_fmamk_f32 v63, v10, 0x40400000, v9
    v_fmamk_f32 v64, v10, 0x41800000, v9
    v_fmamk_f32 v65, v10, 0x41880000, v9
    v_fmamk_f32 v66, v10, 0x41900000, v9
    v_fmamk_f32 v67, v10, 0x41980000, v9
    v_sin_f32 v68, v60
    v_sin_f32 v69, v61
    v_sin_f32 v70, v62
    v_sin_f32 v71, v63
    v_sin_f32 v72, v64
    v_sin_f32 v73, v65
    v_sin_f32 v74, v66
    v_sin_f32 v75, v67
    v_cos_f32 v60, v60
    v_cos_f32 v61, v61
    v_cos_f32 v62, v62
    v_cos_f32 v63, v63
    v_cos_f32 v64, v64
    v_cos_f32 v65, v65
    v_cos_f32 v66, v66
    v_cos_f32 v67, v67
    v_cvt_pk_bf16_f32 v56, v68, v69
    v_cvt_pk_bf16_f32 v57, v70, v71
    v_cvt_pk_bf16_f32 v58, v72, v73
    v_cvt_pk_bf16_f32 v59, v74, v75
    v_cvt_pk_bf16_f32 v52, v60, v61
    v_cvt_pk_bf16_f32 v53, v62, v63
    v_cvt_pk_bf16_f32 v54, v64, v65
    v_cvt_pk_bf16_f32 v55, v66, v67
    v_mul_u32_u24 v7, 2576, v19
    v_lshl_add_u32 v80, v43, 2, v7
    v_add_u32 v80, 82432, v80
    v_add_u32 v81, 128, v80
    v_mul_u32_u24 v7, 2576, v20
    v_add_u32 v7, 82432, v7
    v_sub_u32 v8, 31, v43
    v_lshl_add_u32 v82, v8, 2, v7
    v_add_u32 v83, 128, v82
    v_add_u32 v8, 1, v8
    v_and_b32 v8, 31, v8
    v_lshl_add_u32 v84, v8, 2, v7
    v_lshlrev_b32 v85, 4, v4
    v_readlane_b32 s60, v18, 0
    v_readlane_b32 s61, v18, 32
    s_mul_i32 s60, s60, 1280
    s_mul_i32 s61, s61, 1280
    s_add_u32 s24, s60, 1024
    s_sub_u32 s25, s61, 256
    v_mov_b32 v7, s24
    v_mov_b32 v8, s25
    v_cmp_gt_u32 vcc, 16, v4
    s_nop 1
    v_cndmask_b32 v7, v8, v7, vcc
    v_add_u32 v86, v7, v85
    s_add_u32 s61, s61, 768
    s_mul_i32 s62, s22, 2560
    s_add_u32 s62, s62, 16384
    v_mul_u32_u24 v87, 40, v4
    v_add_u32 v87, s62, v87
    s_waitcnt lgkmcnt(0)
    s_mov_b32 s24, 0xffff0000
    v_lshlrev_b32 v88, 16, v22
    v_lshlrev_b32 v89, 16, v23
    v_and_b32 v90, s24, v22
    v_and_b32 v91, s24, v23
    v_lshlrev_b32 v92, 16, v24
    v_lshlrev_b32 v93, 16, v25
    v_and_b32 v94, s24, v24
    v_and_b32 v95, s24, v25
    v_lshlrev_b32 v96, 16, v26
    v_lshlrev_b32 v97, 16, v27
    v_and_b32 v98, s24, v26
    v_and_b32 v99, s24, v27
    v_lshlrev_b32 v100, 16, v28
    v_lshlrev_b32 v101, 16, v29
    v_and_b32 v102, s24, v28
    v_and_b32 v103, s24, v29
    v_lshlrev_b32 v104, 16, v30
    v_lshlrev_b32 v105, 16, v31
    v_and_b32 v106, s24, v30
    v_and_b32 v107, s24, v31
    v_lshlrev_b32 v108, 16, v32
    v_lshlrev_b32 v109, 16, v33
    v_and_b32 v110, s24, v32
    v_and_b32 v111, s24, v33
    v_lshlrev_b32 v112, 16, v34
    v_lshlrev_b32 v113, 16, v35
    v_and_b32 v114, s24, v34
    v_and_b32 v115, s24, v35
    v_lshlrev_b32 v116, 16, v36
    v_lshlrev_b32 v117, 16, v37
    v_and_b32 v118, s24, v36
    v_and_b32 v119, s24, v37
    v_lshlrev_b32 v120, 16, v38
    v_lshlrev_b32 v121, 16, v39
    v_and_b32 v122, s24, v38
    v_and_b32 v123, s24, v39
    v_lshlrev_b32 v124, 16, v40
    v_lshlrev_b32 v125, 16, v41
    v_and_b32 v126, s24, v40
    v_and_b32 v127, s24, v41
    v_pk_add_f32 v[128:129], v[108:109], v[110:111]
    v_pk_add_f32 v[128:129], v[128:129], v[112:113]
    v_pk_add_f32 v[128:129], v[128:129], v[114:115]
    v_pk_add_f32 v[128:129], v[128:129], v[116:117]
    v_pk_add_f32 v[128:129], v[128:129], v[118:119]
    v_pk_add_f32 v[128:129], v[128:129], v[120:121]
    v_pk_add_f32 v[128:129], v[128:129], v[122:123]
    v_pk_add_f32 v[128:129], v[128:129], v[124:125]
    v_pk_add_f32 v[128:129], v[128:129], v[126:127]
    v_add_f32 v128, v128, v129
    s_nop 1
    v_add_f32_dpp v128, v128, v128 row_ror:8 row_mask:0xf bank_mask:0xf
    s_nop 1
    v_add_f32_dpp v128, v128, v128 row_ror:4 row_mask:0xf bank_mask:0xf
    s_nop 1
    v_add_f32_dpp v128, v128, v128 row_ror:2 row_mask:0xf bank_mask:0xf
    s_nop 1
    v_add_f32_dpp v128, v128, v128 row_ror:1 row_mask:0xf bank_mask:0xf
    v_mov_b32 v7, v128
    s_nop 1
    v_permlane16_swap_b32 v128, v7
    v_add_f32 v128, v128, v7
    s_barrier
    v_mov_b32 v2, 152192
    s_mov_b32 s42, 131072
    s_lshl_b32 s42, s42, 3
F_go:
    ds_read_b32 v3, v2
    s_waitcnt lgkmcnt(0)
    v_cmp_eq_u32 vcc, 0, v3
    s_sub_u32 s42, s42, 1
    s_cselect_b64 vcc, 0, vcc
    s_cbranch_vccnz F_go
    s_mul_i32 s24, s22, 20544
    s_mul_i32 s25, s20, 81920
    s_mul_i32 s26, s22, 20480
    s_add_u32 s25, s25, s26
    s_add_u32 m0, s24, 0
    s_add_u32 s26, s25, 0
    buffer_load_dwordx4 v85, s[12:15], s26 offen offset:0 sc1 lds
    buffer_load_dwordx4 v85, s[12:15], s26 offen offset:1024 sc1 lds
    s_add_u32 m0, s24, 2568
    s_add_u32 s26, s25, 2560
    buffer_load_dwordx4 v85, s[12:15], s26 offen offset:0 sc1 lds
    buffer_load_dwordx4 v85, s[12:15], s26 offen offset:1024 sc1 lds
    s_add_u32 m0, s24, 5136
    s_add_u32 s26, s25, 5120
    buffer_load_dwordx4 v85, s[12:15], s26 offen offset:0 sc1 lds
    buffer_load_dwordx4 v85, s[12:15], s26 offen offset:1024 sc1 lds
    s_add_u32 m0, s24, 7704
    s_add_u32 s26, s25, 7680
    buffer_load_dwordx4 v85, s[12:15], s26 offen offset:0 sc1 lds
    buffer_load_dwordx4 v85, s[12:15], s26 offen offset:1024 sc1 lds
    s_add_u32 m0, s24, 10272
    s_add_u32 s26, s25, 10240
    buffer_load_dwordx4 v85, s[12:15], s26 offen offset:0 sc1 lds
    buffer_load_dwordx4 v85, s[12:15], s26 offen offset:1024 sc1 lds
    s_add_u32 m0, s24, 12840
    s_add_u32 s26, s25, 12800
    buffer_load_dwordx4 v85, s[12:15], s26 offen offset:0 sc1 lds
    buffer_load_dwordx4 v85, s[12:15], s26 offen offset:1024 sc1 lds
    s_add_u32 m0, s24, 15408
    s_add_u32 s26, s25, 15360
    buffer_load_dwordx4 v85, s[12:15], s26 offen offset:0 sc1 lds
    buffer_load_dwordx4 v85, s[12:15], s26 offen offset:1024 sc1 lds
    s_add_u32 m0, s24, 17976
    s_add_u32 s26, s25, 17920
    buffer_load_dwordx4 v85, s[12:15], s26 offen offset:0 sc1 lds
    buffer_load_dwordx4 v85, s[12:15], s26 offen offset:1024 sc1 lds
    s_mov_b32 exec_hi, 0
    s_add_u32 m0, s24, 0
    s_add_u32 s26, s25, 0
    buffer_load_dwordx4 v85, s[12:15], s26 offen offset:2048 sc1 lds
    s_add_u32 m0, s24, 2568
    s_add_u32 s26, s25, 2560
    buffer_load_dwordx4 v85, s[12:15], s26 offen offset:2048 sc1 lds
    s_add_u32 m0, s24, 5136
    s_add_u32 s26, s25, 5120
    buffer_load_dwordx4 v85, s[12:15], s26 offen offset:2048 sc1 lds
    s_add_u32 m0, s24, 7704
    s_add_u32 s26, s25, 7680
    buffer_load_dwordx4 v85, s[12:15], s26 offen offset:2048 sc1 lds
    s_add_u32 m0, s24, 10272
    s_add_u32 s26, s25, 10240
    buffer_load_dwordx4 v85, s[12:15], s26 offen offset:2048 sc1 lds
    s_add_u32 m0, s24, 12840
    s_add_u32 s26, s25, 12800
    buffer_load_dwordx4 v85, s[12:15], s26 offen offset:2048 sc1 lds
    s_add_u32 m0, s24, 15408
    s_add_u32 s26, s25, 15360
    buffer_load_dwordx4 v85, s[12:15], s26 offen offset:2048 sc1 lds
    s_add_u32 m0, s24, 17976
    s_add_u32 s26, s25, 17920
    buffer_load_dwordx4 v85, s[12:15], s26 offen offset:2048 sc1 lds
    s_mov_b32 exec_hi, -1
    s_waitcnt vmcnt(0)
    s_barrier
    ds_read_b64_tr_b16 v[130:131], v76 offset:0
    ds_read_b64_tr_b16 v[132:133], v76 offset:20544
    ds_read_b64_tr_b16 v[134:135], v76 offset:1280
    ds_read_b64_tr_b16 v[136:137], v76 offset:21824
    ds_read_b64_tr_b16 v[138:139], v76 offset:160
    ds_read_b64_tr_b16 v[140:141], v76 offset:20704
    ds_read_b64_tr_b16 v[142:143], v76 offset:1440
    ds_read_b64_tr_b16 v[144:145], v76 offset:21984
    ds_read_b64_tr_b16 v[146:147], v76 offset:8
    ds_read_b64_tr_b16 v[148:149], v76 offset:20552
    ds_read_b64_tr_b16 v[150:151], v76 offset:1288
    ds_read_b64_tr_b16 v[152:153], v76 offset:21832
    ds_read_b64_tr_b16 v[154:155], v76 offset:168
    ds_read_b64_tr_b16 v[156:157], v76 offset:20712
    ds_read_b64_tr_b16 v[158:159], v76 offset:1448
    ds_read_b64_tr_b16 v[160:161], v76 offset:21992
    s_waitcnt lgkmcnt(8)
    v_mfma_f32_16x16x32_bf16 v[210:213], v[130:133], v[44:47], 0
    v_mfma_f32_16x16x32_bf16 v[214:217], v[134:137], v[44:47], 0
    v_mfma_f32_16x16x32_bf16 v[210:213], v[138:141], v[48:51], v[210:213]
    v_mfma_f32_16x16x32_bf16 v[214:217], v[142:145], v[48:51], v[214:217]
    ds_read_b64_tr_b16 v[162:163], v76 offset:16
    ds_read_b64_tr_b16 v[164:165], v76 offset:20560
    ds_read_b64_tr_b16 v[166:167], v76 offset:1296
    ds_read_b64_tr_b16 v[168:169], v76 offset:21840
    ds_read_b64_tr_b16 v[170:171], v76 offset:176
    ds_read_b64_tr_b16 v[172:173], v76 offset:20720
    ds_read_b64_tr_b16 v[174:175], v76 offset:1456
    ds_read_b64_tr_b16 v[176:177], v76 offset:22000
    s_waitcnt lgkmcnt(8)
    v_mfma_f32_16x16x32_bf16 v[218:221], v[146:149], v[44:47], 0
    v_mfma_f32_16x16x32_bf16 v[222:225], v[150:153], v[44:47], 0
    v_mfma_f32_16x16x32_bf16 v[218:221], v[154:157], v[48:51], v[218:221]
    v_mfma_f32_16x16x32_bf16 v[222:225], v[158:161], v[48:51], v[222:225]
    ds_read_b64_tr_b16 v[178:179], v76 offset:24
    ds_read_b64_tr_b16 v[180:181], v76 offset:20568
    ds_read_b64_tr_b16 v[182:183], v76 offset:1304
    ds_read_b64_tr_b16 v[184:185], v76 offset:21848
    ds_read_b64_tr_b16 v[186:187], v76 offset:184
    ds_read_b64_tr_b16 v[188:189], v76 offset:20728
    ds_read_b64_tr_b16 v[190:191], v76 offset:1464
    ds_read_b64_tr_b16 v[192:193], v76 offset:22008
    s_waitcnt lgkmcnt(8)
    v_mfma_f32_16x16x32_bf16 v[226:229], v[162:165], v[44:47], 0
    v_mfma_f32_16x16x32_bf16 v[230:233], v[166:169], v[44:47], 0
    v_mfma_f32_16x16x32_bf16 v[226:229], v[170:173], v[48:51], v[226:229]
    v_mfma_f32_16x16x32_bf16 v[230:233], v[174:177], v[48:51], v[230:233]
    ds_read_b64_tr_b16 v[194:195], v76 offset:32
    ds_read_b64_tr_b16 v[196:197], v76 offset:20576
    ds_read_b64_tr_b16 v[198:199], v76 offset:1312
    ds_read_b64_tr_b16 v[200:201], v76 offset:21856
    ds_read_b64_tr_b16 v[202:203], v76 offset:192
    ds_read_b64_tr_b16 v[204:205], v76 offset:20736
    ds_read_b64_tr_b16 v[206:207], v76 offset:1472
    ds_read_b64_tr_b16 v[208:209], v76 offset:22016
    s_waitcnt lgkmcnt(8)
    v_mfma_f32_16x16x32_bf16 v[234:237], v[178:181], v[44:47], 0
    v_mfma_f32_16x16x32_bf16 v[238:241], v[182:185], v[44:47], 0
    v_mfma_f32_16x16x32_bf16 v[234:237], v[186:189], v[48:51], v[234:237]
    v_mfma_f32_16x16x32_bf16 v[238:241], v[190:193], v[48:51], v[238:241]
    s_waitcnt lgkmcnt(0)
    v_mfma_f32_16x16x32_bf16 v[242:245], v[194:197], v[44:47], 0
    v_mfma_f32_16x16x32_bf16 v[246:249], v[198:201], v[44:47], 0
    v_mfma_f32_16x16x32_bf16 v[242:245], v[202:205], v[48:51], v[242:245]
    v_mfma_f32_16x16x32_bf16 v[246:249], v[206:209], v[48:51], v[246:249]
    v_cvt_pk_bf16_f32 v130, v210, v211
    v_cvt_pk_bf16_f32 v131, v212, v213
    v_cvt_pk_bf16_f32 v132, v214, v215
    v_cvt_pk_bf16_f32 v133, v216, v217
    v_xor_b32 v170, v79, v130
    v_xor_b32 v171, v79, v131
    v_xor_b32 v172, v79, v132
    v_xor_b32 v173, v79, v133
    v_mov_b32_dpp v170, v130 row_ror:8 row_mask:0xf bank_mask:0x3
    v_mov_b32_dpp v171, v131 row_ror:8 row_mask:0xf bank_mask:0x3
    v_mov_b32_dpp v172, v132 row_ror:8 row_mask:0xf bank_mask:0x3
    v_mov_b32_dpp v173, v133 row_ror:8 row_mask:0xf bank_mask:0x3
    v_xor_b32_dpp v130, v130, v79 row_ror:8 row_mask:0xf bank_mask:0xc
    v_xor_b32_dpp v131, v131, v79 row_ror:8 row_mask:0xf bank_mask:0xc
    v_xor_b32_dpp v132, v132, v79 row_ror:8 row_mask:0xf bank_mask:0xc
    v_xor_b32_dpp v133, v133, v79 row_ror:8 row_mask:0xf bank_mask:0xc
    v_cvt_pk_bf16_f32 v134, v218, v219
    v_cvt_pk_bf16_f32 v135, v220, v221
    v_cvt_pk_bf16_f32 v136, v222, v223
    v_cvt_pk_bf16_f32 v137, v224, v225
    v_xor_b32 v174, v79, v134
    v_xor_b32 v175, v79, v135
    v_xor_b32 v176, v79, v136
    v_xor_b32 v177, v79, v137
    v_mov_b32_dpp v174, v134 row_ror:8 row_mask:0xf bank_mask:0x3
    v_mov_b32_dpp v175, v135 row_ror:8 row_mask:0xf bank_mask:0x3
    v_mov_b32_dpp v176, v136 row_ror:8 row_mask:0xf bank_mask:0x3
    v_mov_b32_dpp v177, v137 row_ror:8 row_mask:0xf bank_mask:0x3
    v_xor_b32_dpp v134, v134, v79 row_ror:8 row_mask:0xf bank_mask:0xc
    v_xor_b32_dpp v135, v135, v79 row_ror:8 row_mask:0xf bank_mask:0xc
    v_xor_b32_dpp v136, v136, v79 row_ror:8 row_mask:0xf bank_mask:0xc
    v_xor_b32_dpp v137, v137, v79 row_ror:8 row_mask:0xf bank_mask:0xc
    v_mfma_f32_16x16x32_bf16 v[150:153], v[52:55], v[130:133], 0
    v_mfma_f32_16x16x32_bf16 v[150:153], v[56:59], v[170:173], v[150:153]
    v_cvt_pk_bf16_f32 v138, v226, v227
    v_cvt_pk_bf16_f32 v139, v228, v229
    v_cvt_pk_bf16_f32 v140, v230, v231
    v_cvt_pk_bf16_f32 v141, v232, v233
    v_xor_b32 v178, v79, v138
    v_xor_b32 v179, v79, v139
    v_xor_b32 v180, v79, v140
    v_xor_b32 v181, v79, v141
    v_mov_b32_dpp v178, v138 row_ror:8 row_mask:0xf bank_mask:0x3
    v_mov_b32_dpp v179, v139 row_ror:8 row_mask:0xf bank_mask:0x3
    v_mov_b32_dpp v180, v140 row_ror:8 row_mask:0xf bank_mask:0x3
    v_mov_b32_dpp v181, v141 row_ror:8 row_mask:0xf bank_mask:0x3
    v_xor_b32_dpp v138, v138, v79 row_ror:8 row_mask:0xf bank_mask:0xc
    v_xor_b32_dpp v139, v139, v79 row_ror:8 row_mask:0xf bank_mask:0xc
    v_xor_b32_dpp v140, v140, v79 row_ror:8 row_mask:0xf bank_mask:0xc
    v_xor_b32_dpp v141, v141, v79 row_ror:8 row_mask:0xf bank_mask:0xc
    v_mfma_f32_16x16x32_bf16 v[154:157], v[52:55], v[134:137], 0
    v_mfma_f32_16x16x32_bf16 v[154:157], v[56:59], v[174:177], v[154:157]
    v_cvt_pk_bf16_f32 v142, v234, v235
    v_cvt_pk_bf16_f32 v143, v236, v237
    v_cvt_pk_bf16_f32 v144, v238, v239
    v_cvt_pk_bf16_f32 v145, v240, v241
    v_xor_b32 v182, v79, v142
    v_xor_b32 v183, v79, v143
    v_xor_b32 v184, v79, v144
    v_xor_b32 v185, v79, v145
    v_mov_b32_dpp v182, v142 row_ror:8 row_mask:0xf bank_mask:0x3
    v_mov_b32_dpp v183, v143 row_ror:8 row_mask:0xf bank_mask:0x3
    v_mov_b32_dpp v184, v144 row_ror:8 row_mask:0xf bank_mask:0x3
    v_mov_b32_dpp v185, v145 row_ror:8 row_mask:0xf bank_mask:0x3
    v_xor_b32_dpp v142, v142, v79 row_ror:8 row_mask:0xf bank_mask:0xc
    v_xor_b32_dpp v143, v143, v79 row_ror:8 row_mask:0xf bank_mask:0xc
    v_xor_b32_dpp v144, v144, v79 row_ror:8 row_mask:0xf bank_mask:0xc
    v_xor_b32_dpp v145, v145, v79 row_ror:8 row_mask:0xf bank_mask:0xc
    v_mfma_f32_16x16x32_bf16 v[158:161], v[52:55], v[138:141], 0
    v_mfma_f32_16x16x32_bf16 v[158:161], v[56:59], v[178:181], v[158:161]
    v_cvt_pk_bf16_f32 v146, v242, v243
    v_cvt_pk_bf16_f32 v147, v244, v245
    v_cvt_pk_bf16_f32 v148, v246, v247
    v_cvt_pk_bf16_f32 v149, v248, v249
    v_xor_b32 v186, v79, v146
    v_xor_b32 v187, v79, v147
    v_xor_b32 v188, v79, v148
    v_xor_b32 v189, v79, v149
    v_mov_b32_dpp v186, v146 row_ror:8 row_mask:0xf bank_mask:0x3
    v_mov_b32_dpp v187, v147 row_ror:8 row_mask:0xf bank_mask:0x3
    v_mov_b32_dpp v188, v148 row_ror:8 row_mask:0xf bank_mask:0x3
    v_mov_b32_dpp v189, v149 row_ror:8 row_mask:0xf bank_mask:0x3
    v_xor_b32_dpp v146, v146, v79 row_ror:8 row_mask:0xf bank_mask:0xc
    v_xor_b32_dpp v147, v147, v79 row_ror:8 row_mask:0xf bank_mask:0xc
    v_xor_b32_dpp v148, v148, v79 row_ror:8 row_mask:0xf bank_mask:0xc
    v_xor_b32_dpp v149, v149, v79 row_ror:8 row_mask:0xf bank_mask:0xc
    v_mfma_f32_16x16x32_bf16 v[162:165], v[52:55], v[142:145], 0
    v_mfma_f32_16x16x32_bf16 v[162:165], v[56:59], v[182:185], v[162:165]
    v_mfma_f32_16x16x32_bf16 v[166:169], v[52:55], v[146:149], 0
    v_mfma_f32_16x16x32_bf16 v[166:169], v[56:59], v[186:189], v[166:169]
    ds_write_b128 v77, v[150:153] offset:0
    ds_write_b128 v77, v[154:157] offset:128
    ds_write_b128 v77, v[158:161] offset:256
    s_nop 2
    ds_write_b128 v77, v[162:165] offset:384
    s_nop 0
    ds_write_b128 v78, v[166:169]
    s_waitcnt lgkmcnt(0)
    s_barrier
    ds_read2st64_b32 v[210:211], v80 offset0:0 offset1:1
    ds_read2st64_b32 v[212:213], v81 offset0:0 offset1:1
    ds_read_b32 v230, v84
    ds_read_b32 v231, v82 offset:2304
    ds_read2st64_b32 v[232:233], v83 offset0:9 offset1:8
    ds_read2st64_b32 v[214:215], v80 offset0:2 offset1:3
    ds_read2st64_b32 v[216:217], v81 offset0:2 offset1:3
    ds_read2st64_b32 v[234:235], v82 offset0:8 offset1:7
    ds_read2st64_b32 v[236:237], v83 offset0:7 offset1:6
    ds_read2st64_b32 v[218:219], v80 offset0:4 offset1:5
    ds_read2st64_b32 v[220:221], v81 offset0:4 offset1:5
    ds_read2st64_b32 v[238:239], v82 offset0:6 offset1:5
    ds_read2st64_b32 v[240:241], v83 offset0:5 offset1:4
    ds_read2st64_b32 v[222:223], v80 offset0:6 offset1:7
    ds_read2st64_b32 v[224:225], v81 offset0:6 offset1:7
    ds_read2st64_b32 v[242:243], v82 offset0:4 offset1:3
    ds_read2st64_b32 v[244:245], v83 offset0:3 offset1:2
    ds_read2st64_b32 v[226:227], v80 offset0:8 offset1:9
    ds_read2st64_b32 v[228:229], v81 offset0:8 offset1:9
    ds_read2st64_b32 v[246:247], v82 offset0:2 offset1:1
    ds_read2st64_b32 v[248:249], v83 offset0:1 offset1:0
    s_waitcnt lgkmcnt(15)
    v_pk_add_f32 v[210:211], v[210:211], v[230:231]
    v_pk_add_f32 v[212:213], v[212:213], v[232:233]
    v_pk_add_f32 v[88:89], v[88:89], v[210:211]
    v_pk_add_f32 v[90:91], v[90:91], v[212:213]
    v_pk_mul_f32 v[132:133], v[88:89], v[88:89]
    v_pk_mul_f32 v[134:135], v[88:89], v[108:109]
    v_pk_fma_f32 v[132:133], v[90:91], v[90:91], v[132:133]
    v_pk_fma_f32 v[134:135], v[90:91], v[110:111], v[134:135]
    v_pk_add_f32 v[130:131], v[88:89], v[90:91]
    s_waitcnt lgkmcnt(12)
    v_pk_add_f32 v[214:215], v[214:215], v[234:235]
    v_pk_add_f32 v[216:217], v[216:217], v[236:237]
    v_pk_add_f32 v[92:93], v[92:93], v[214:215]
    v_pk_add_f32 v[94:95], v[94:95], v[216:217]
    v_pk_fma_f32 v[132:133], v[92:93], v[92:93], v[132:133]
    v_pk_fma_f32 v[134:135], v[92:93], v[112:113], v[134:135]
    v_pk_add_f32 v[130:131], v[130:131], v[92:93]
    v_pk_fma_f32 v[132:133], v[94:95], v[94:95], v[132:133]
    v_pk_fma_f32 v[134:135], v[94:95], v[114:115], v[134:135]
    v_pk_add_f32 v[130:131], v[130:131], v[94:95]
    s_waitcnt lgkmcnt(8)
    v_pk_add_f32 v[218:219], v[218:219], v[238:239]
    v_pk_add_f32 v[220:221], v[220:221], v[240:241]
    v_pk_add_f32 v[96:97], v[96:97], v[218:219]
    v_pk_add_f32 v[98:99], v[98:99], v[220:221]
    v_pk_fma_f32 v[132:133], v[96:97], v[96:97], v[132:133]
    v_pk_fma_f32 v[134:135], v[96:97], v[116:117], v[134:135]
    v_pk_add_f32 v[130:131], v[130:131], v[96:97]
    v_pk_fma_f32 v[132:133], v[98:99], v[98:99], v[132:133]
    v_pk_fma_f32 v[134:135], v[98:99], v[118:119], v[134:135]
    v_pk_add_f32 v[130:131], v[130:131], v[98:99]
    s_waitcnt lgkmcnt(4)
    v_pk_add_f32 v[222:223], v[222:223], v[242:243]
    v_pk_add_f32 v[224:225], v[224:225], v[244:245]
    v_pk_add_f32 v[100:101], v[100:101], v[222:223]
    v_pk_add_f32 v[102:103], v[102:103], v[224:225]
    v_pk_fma_f32 v[132:133], v[100:101], v[100:101], v[132:133]
    v_pk_fma_f32 v[134:135], v[100:101], v[120:121], v[134:135]
    v_pk_add_f32 v[130:131], v[130:131], v[100:101]
    v_pk_fma_f32 v[132:133], v[102:103], v[102:103], v[132:133]
    v_pk_fma_f32 v[134:135], v[102:103], v[122:123], v[134:135]
    v_pk_add_f32 v[130:131], v[130:131], v[102:103]
    s_waitcnt lgkmcnt(0)
    v_pk_add_f32 v[226:227], v[226:227], v[246:247]
    v_pk_add_f32 v[228:229], v[228:229], v[248:249]
    v_pk_add_f32 v[104:105], v[104:105], v[226:227]
    v_pk_add_f32 v[106:107], v[106:107], v[228:229]
    v_pk_fma_f32 v[132:133], v[104:105], v[104:105], v[132:133]
    v_pk_fma_f32 v[134:135], v[104:105], v[124:125], v[134:135]
    v_pk_add_f32 v[130:131], v[130:131], v[104:105]
    v_pk_fma_f32 v[132:133], v[106:107], v[106:107], v[132:133]
    v_pk_fma_f32 v[134:135], v[106:107], v[126:127], v[134:135]
    v_pk_add_f32 v[130:131], v[130:131], v[106:107]
    v_add_f32 v130, v130, v131
    v_add_f32 v132, v132, v133
    v_add_f32 v134, v134, v135
    v_add_f32_dpp v130, v130, v130 row_ror:8 row_mask:0xf bank_mask:0xf
    v_add_f32_dpp v132, v132, v132 row_ror:8 row_mask:0xf bank_mask:0xf
    v_add_f32_dpp v134, v134, v134 row_ror:8 row_mask:0xf bank_mask:0xf
    v_add_f32_dpp v130, v130, v130 row_ror:4 row_mask:0xf bank_mask:0xf
    v_add_f32_dpp v132, v132, v132 row_ror:4 row_mask:0xf bank_mask:0xf
    v_add_f32_dpp v134, v134, v134 row_ror:4 row_mask:0xf bank_mask:0xf
    v_add_f32_dpp v130, v130, v130 row_ror:2 row_mask:0xf bank_mask:0xf
    v_add_f32_dpp v132, v132, v132 row_ror:2 row_mask:0xf bank_mask:0xf
    v_add_f32_dpp v134, v134, v134 row_ror:2 row_mask:0xf bank_mask:0xf
    v_add_f32_dpp v130, v130, v130 row_ror:1 row_mask:0xf bank_mask:0xf
    v_add_f32_dpp v132, v132, v132 row_ror:1 row_mask:0xf bank_mask:0xf
    v_add_f32_dpp v134, v134, v134 row_ror:1 row_mask:0xf bank_mask:0xf
    v_mov_b32 v7, v130
    v_mov_b32 v8, v132
    v_mov_b32 v9, v134
    v_permlane16_swap_b32 v130, v7
    v_permlane16_swap_b32 v132, v8
    v_permlane16_swap_b32 v134, v9
    v_add_f32 v130, v130, v7
    v_add_f32 v132, v132, v8
    v_add_f32 v134, v134, v9
    v_mul_f32 v141, 0x3acccccd, v130
    v_mul_f32 v132, 0x3acccccd, v132
    v_fma_f32 v132, -v141, v141, v132
    v_max_f32 v132, 0, v132
    v_cvt_pk_bf16_f32 v7, v132, v132
    v_lshlrev_b32 v132, 16, v7
    v_add_f32 v132, 0x3727c5ac, v132
    v_cvt_pk_bf16_f32 v7, v132, v132
    v_lshlrev_b32 v132, 16, v7
    v_sqrt_f32 v132, v132
    s_nop 0
    v_cvt_pk_bf16_f32 v7, v132, v132
    v_lshlrev_b32 v132, 16, v7
    v_rcp_f32 v132, v132
    v_fma_f32 v134, -v141, v128, v134
    v_add_f32 v136, 1.0, v132
    v_mul_f32 v138, v141, v132
    v_rcp_f32 v140, v136
    v_mul_f32 v134, v134, v132
    v_ashrrev_i32 v7, 31, v134
    v_or_b32 v7, v79, v7
    v_xor_b32 v7, v7, v134
    v_and_b32 v7, 0xfffff800, v7
    v_sub_u32 v8, 0x7ff, v18
    v_or_b32 v7, v7, v8
    v_max_u32 v7, 1, v7
    v_lshrrev_b32 v9, 5, v0
    v_lshlrev_b32 v9, 2, v9
    ds_write_b32 v9, v7 offset:8448
    v_mul_f32 v140, v140, v132
    v_lshlrev_b32 v10, 7, v18
    v_add_u32 v9, s62, v85
    s_mov_b32 s25, 2719744
    s_waitcnt lgkmcnt(0)
    s_barrier
    v_pk_fma_f32 v[88:89], v[88:89], v[136:137], v[138:139] op_sel_hi:[1,0,0] neg_lo:[0,0,1] neg_hi:[0,0,1]
    v_pk_fma_f32 v[90:91], v[90:91], v[136:137], v[138:139] op_sel_hi:[1,0,0] neg_lo:[0,0,1] neg_hi:[0,0,1]
    v_pk_fma_f32 v[92:93], v[92:93], v[136:137], v[138:139] op_sel_hi:[1,0,0] neg_lo:[0,0,1] neg_hi:[0,0,1]
    v_pk_fma_f32 v[94:95], v[94:95], v[136:137], v[138:139] op_sel_hi:[1,0,0] neg_lo:[0,0,1] neg_hi:[0,0,1]
    v_pk_fma_f32 v[96:97], v[96:97], v[136:137], v[138:139] op_sel_hi:[1,0,0] neg_lo:[0,0,1] neg_hi:[0,0,1]
    v_pk_fma_f32 v[98:99], v[98:99], v[136:137], v[138:139] op_sel_hi:[1,0,0] neg_lo:[0,0,1] neg_hi:[0,0,1]
    v_pk_fma_f32 v[100:101], v[100:101], v[136:137], v[138:139] op_sel_hi:[1,0,0] neg_lo:[0,0,1] neg_hi:[0,0,1]
    v_pk_fma_f32 v[102:103], v[102:103], v[136:137], v[138:139] op_sel_hi:[1,0,0] neg_lo:[0,0,1] neg_hi:[0,0,1]
    v_pk_fma_f32 v[104:105], v[104:105], v[136:137], v[138:139] op_sel_hi:[1,0,0] neg_lo:[0,0,1] neg_hi:[0,0,1]
    v_pk_fma_f32 v[106:107], v[106:107], v[136:137], v[138:139] op_sel_hi:[1,0,0] neg_lo:[0,0,1] neg_hi:[0,0,1]
    v_cvt_pk_bf16_f32 v142, v88, v90
    v_cvt_pk_bf16_f32 v143, v89, v91
    ds_write_b64 v87, v[142:143] offset:0
    v_cvt_pk_bf16_f32 v144, v92, v94
    v_cvt_pk_bf16_f32 v145, v93, v95
    ds_write_b64 v87, v[144:145] offset:8
    v_cvt_pk_bf16_f32 v146, v96, v98
    v_cvt_pk_bf16_f32 v147, v97, v99
    ds_write_b64 v87, v[146:147] offset:16
    v_cvt_pk_bf16_f32 v148, v100, v102
    v_cvt_pk_bf16_f32 v149, v101, v103
    ds_write_b64 v87, v[148:149] offset:24
    v_cvt_pk_bf16_f32 v150, v104, v106
    v_cvt_pk_bf16_f32 v151, v105, v107
    ds_write_b64 v87, v[150:151] offset:32
    s_waitcnt lgkmcnt(0)
    ds_read_b128 v[154:157], v9 offset:0
    ds_read_b128 v[158:161], v9 offset:1024
    ds_read_b128 v[162:165], v9 offset:2048
    s_barrier
    s_waitcnt lgkmcnt(2)
    buffer_store_dwordx4 v[154:157], v85, s[16:19], s60 offen sc1
    s_waitcnt lgkmcnt(1)
    buffer_store_dwordx4 v[158:161], v86, s[16:19], 0 offen sc1
    s_waitcnt lgkmcnt(0)
    s_mov_b32 exec_hi, 0
    buffer_store_dwordx4 v[162:165], v85, s[16:19], s61 offen sc1
    s_mov_b32 exec_hi, -1
    s_mov_b32 exec_lo, 1
    s_mov_b32 exec_hi, 1
    buffer_store_dwordx2 v[140:141], v10, s[12:15], s25 offen sc1
    s_mov_b64 exec, -1
    s_cmp_ge_u32 s2, 136
    s_cbranch_scc1 F_fin
    v_and_b32 v12, 63, v0
    v_lshrrev_b32 v13, 4, v12
    v_and_b32 v14, 15, v12
    v_and_b32 v16, 1, v12
    v_lshlrev_b32 v21, 2, v16
    s_mov_b32 s36, 0x00030003
    s_mov_b32 s37, 0x00030003
    s_cmp_ge_u32 s2, 96
    s_cbranch_scc1 F_c2
    s_mul_i32 s24, s22, 320
    v_lshl_add_u32 v22, v13, 4, s24
    s_mov_b32 s26, 2719744
    s_movk_i32 s27, 1280
    v_mov_b32 v24, 0x3f803f80
    v_mov_b32 v25, 0x3f803f80
    v_mov_b32 v26, 0x3f803f80
    v_mov_b32 v27, 0x3f803f80
    v_mov_b32 v28, 0x3f803f80
    v_mov_b32 v29, 0x3f803f80
    v_mov_b32 v30, 0x3f803f80
    v_mov_b32 v31, 0x3f803f80
    v_mov_b32 v32, 0x3f803f80
    v_mov_b32 v33, 0x3f803f80
    v_mov_b32 v34, 0x3f803f80
    v_mov_b32 v35, 0x3f803f80
    v_mov_b32 v36, 0x3f803f80
    v_mov_b32 v37, 0x3f803f80
    v_mov_b32 v38, 0x3f803f80
    v_mov_b32 v39, 0x3f803f80
    v_mov_b32 v40, 0x3f803f80
    v_mov_b32 v41, 0x3f803f80
    v_mov_b32 v42, 0x3f803f80
    v_mov_b32 v43, 0x3f803f80
    s_mov_b32 s42, 131072
    v_lshrrev_b32 v15, 1, v13
    v_and_b32 v16, 1, v13
    v_lshlrev_b32 v15, 9, v15
    v_lshl_add_u32 v15, v16, 7, v15
    v_lshl_add_u32 v15, v14, 3, v15
    s_mul_i32 s24, s22, 5120
    s_add_u32 s24, s24, 103040
    v_add_u32 v92, s24, v15
    s_barrier
    ds_read_b32 v6, v21 offset:8512
    s_waitcnt lgkmcnt(0)
    v_and_b32 v7, 0x7ff, v6
    v_sub_u32 v7, 0x7ff, v7
    v_mad_u32_u24 v17, v7, s27, v22
    v_lshlrev_b32 v18, 7, v7
    s_mov_b64 exec, s[36:37]
    buffer_load_dwordx4 v[24:27], v17, s[16:19], 0 offen offset:0 sc1
    buffer_load_dwordx4 v[28:31], v17, s[16:19], 0 offen offset:64 sc1
    buffer_load_dwordx4 v[32:35], v17, s[16:19], 0 offen offset:128 sc1
    buffer_load_dwordx4 v[36:39], v17, s[16:19], 0 offen offset:192 sc1
    buffer_load_dwordx4 v[40:43], v17, s[16:19], 0 offen offset:256 sc1
    buffer_load_dwordx2 v[8:9], v18, s[12:15], s26 offen sc1
    s_mov_b64 exec, -1
    ds_read_b64_tr_b16 v[44:45], v92 offset:0
    ds_read_b64_tr_b16 v[46:47], v92 offset:256
    ds_read_b64_tr_b16 v[48:49], v92 offset:20480
    ds_read_b64_tr_b16 v[50:51], v92 offset:20736
    ds_read_b64_tr_b16 v[52:53], v92 offset:1024
    ds_read_b64_tr_b16 v[54:55], v92 offset:1280
    ds_read_b64_tr_b16 v[56:57], v92 offset:21504
    ds_read_b64_tr_b16 v[58:59], v92 offset:21760
    ds_read_b64_tr_b16 v[60:61], v92 offset:2048
    ds_read_b64_tr_b16 v[62:63], v92 offset:2304
    ds_read_b64_tr_b16 v[64:65], v92 offset:22528
    ds_read_b64_tr_b16 v[66:67], v92 offset:22784
    ds_read_b64_tr_b16 v[68:69], v92 offset:3072
    ds_read_b64_tr_b16 v[70:71], v92 offset:3328
    ds_read_b64_tr_b16 v[72:73], v92 offset:23552
    ds_read_b64_tr_b16 v[74:75], v92 offset:23808
    ds_read_b64_tr_b16 v[76:77], v92 offset:4096
    ds_read_b64_tr_b16 v[78:79], v92 offset:4352
    ds_read_b64_tr_b16 v[80:81], v92 offset:24576
    ds_read_b64_tr_b16 v[82:83], v92 offset:24832
    v_lshlrev_b32 v94, 4, v12
    s_lshl_b32 s25, s22, 11
    v_add_u32 v93, s25, v94
    v_lshlrev_b32 v95, 4, v14
    v_lshl_add_u32 v95, v13, 4, v95
    s_mov_b64 exec, s[36:37]
    s_branch C1_chk
C1_poll:
    buffer_load_dwordx4 v[24:27], v17, s[16:19], 0 offen offset:0 sc1
    buffer_load_dwordx4 v[28:31], v17, s[16:19], 0 offen offset:64 sc1
    buffer_load_dwordx4 v[32:35], v17, s[16:19], 0 offen offset:128 sc1
    buffer_load_dwordx4 v[36:39], v17, s[16:19], 0 offen offset:192 sc1
    buffer_load_dwordx4 v[40:43], v17, s[16:19], 0 offen offset:256 sc1
    buffer_load_dwordx2 v[8:9], v18, s[12:15], s26 offen sc1
C1_chk:
    s_waitcnt vmcnt(0)
    v_max3_u32 v15, v24, v26, v28
    v_max3_u32 v15, v15, v30, v32
    v_max3_u32 v15, v15, v34, v36
    v_max3_u32 v15, v15, v38, v40
    v_max3_u32 v15, v15, v42, v8
    v_cmp_eq_u32 vcc, -1, v15
    s_sub_u32 s42, s42, 1
    s_cselect_b64 vcc, 0, vcc
    s_cbranch_vccnz C1_poll
    s_mov_b64 exec, -1
    s_waitcnt lgkmcnt(0)
    v_mfma_f32_16x16x32_bf16 v[84:87], v[44:47], v[24:27], 0
    v_mfma_f32_16x16x32_bf16 v[88:91], v[48:51], v[24:27], 0
    v_mfma_f32_16x16x32_bf16 v[84:87], v[52:55], v[28:31], v[84:87]
    v_mfma_f32_16x16x32_bf16 v[88:91], v[56:59], v[28:31], v[88:91]
    v_mfma_f32_16x16x32_bf16 v[84:87], v[60:63], v[32:35], v[84:87]
    v_mfma_f32_16x16x32_bf16 v[88:91], v[64:67], v[32:35], v[88:91]
    v_mfma_f32_16x16x32_bf16 v[84:87], v[68:71], v[36:39], v[84:87]
    v_mfma_f32_16x16x32_bf16 v[88:91], v[72:75], v[36:39], v[88:91]
    v_mfma_f32_16x16x32_bf16 v[84:87], v[76:79], v[40:43], v[84:87]
    v_mfma_f32_16x16x32_bf16 v[88:91], v[80:83], v[40:43], v[88:91]
    v_xor_b32 v9, 0x80000000, v9
    s_nop 5
    v_fmac_f32_dpp v84, v84, v9 row_newbcast:2 row_mask:0xf bank_mask:0xf
    v_fmac_f32_dpp v85, v85, v9 row_newbcast:2 row_mask:0xf bank_mask:0xf
    v_fmac_f32_dpp v86, v86, v9 row_newbcast:2 row_mask:0xf bank_mask:0xf
    v_fmac_f32_dpp v87, v87, v9 row_newbcast:2 row_mask:0xf bank_mask:0xf
    v_fmac_f32_dpp v88, v88, v9 row_newbcast:2 row_mask:0xf bank_mask:0xf
    v_fmac_f32_dpp v89, v89, v9 row_newbcast:2 row_mask:0xf bank_mask:0xf
    v_fmac_f32_dpp v90, v90, v9 row_newbcast:2 row_mask:0xf bank_mask:0xf
    v_fmac_f32_dpp v91, v91, v9 row_newbcast:2 row_mask:0xf bank_mask:0xf
    ds_write_b128 v93, v[84:87]
    ds_write_b128 v93, v[88:91] offset:1024
    s_waitcnt lgkmcnt(0)
    s_barrier
    s_cmp_lg_u32 s22, 0
    s_cbranch_scc1 F_fin
    ds_read_b128 v[44:47], v94 offset:0
    ds_read_b128 v[60:63], v94 offset:1024
    ds_read_b128 v[48:51], v94 offset:2048
    ds_read_b128 v[64:67], v94 offset:3072
    ds_read_b128 v[52:55], v94 offset:4096
    ds_read_b128 v[68:71], v94 offset:5120
    ds_read_b128 v[56:59], v94 offset:6144
    ds_read_b128 v[72:75], v94 offset:7168
    s_lshl_b32 s24, s23, 7
    s_add_u32 s24, s24, 2982144
    s_waitcnt lgkmcnt(0)
    v_pk_add_f32 v[44:45], v[44:45], v[48:49]
    v_pk_add_f32 v[52:53], v[52:53], v[56:57]
    v_pk_add_f32 v[44:45], v[44:45], v[52:53]
    v_pk_mul_f32 v[44:45], v[44:45], v[8:9] op_sel_hi:[1,0]
    v_pk_add_f32 v[46:47], v[46:47], v[50:51]
    v_pk_add_f32 v[54:55], v[54:55], v[58:59]
    v_pk_add_f32 v[46:47], v[46:47], v[54:55]
    v_pk_mul_f32 v[46:47], v[46:47], v[8:9] op_sel_hi:[1,0]
    v_pk_add_f32 v[60:61], v[60:61], v[64:65]
    v_pk_add_f32 v[68:69], v[68:69], v[72:73]
    v_pk_add_f32 v[60:61], v[60:61], v[68:69]
    v_pk_mul_f32 v[60:61], v[60:61], v[8:9] op_sel_hi:[1,0]
    v_pk_add_f32 v[62:63], v[62:63], v[66:67]
    v_pk_add_f32 v[70:71], v[70:71], v[74:75]
    v_pk_add_f32 v[62:63], v[62:63], v[70:71]
    v_pk_mul_f32 v[62:63], v[62:63], v[8:9] op_sel_hi:[1,0]
    v_mul_f32 v48, 0xbfb8aa3b, v44
    v_mul_f32 v49, 0xbfb8aa3b, v45
    v_mul_f32 v50, 0xbfb8aa3b, v46
    v_mul_f32 v51, 0xbfb8aa3b, v47
    v_exp_f32 v48, v48
    v_exp_f32 v49, v49
    v_exp_f32 v50, v50
    v_exp_f32 v51, v51
    v_mul_f32 v44, v44, v60
    v_mul_f32 v45, v45, v61
    v_mul_f32 v46, v46, v62
    v_mul_f32 v47, v47, v63
    v_add_f32 v48, 1.0, v48
    v_add_f32 v49, 1.0, v49
    v_add_f32 v50, 1.0, v50
    v_add_f32 v51, 1.0, v51
    v_rcp_f32 v48, v48
    v_rcp_f32 v49, v49
    v_rcp_f32 v50, v50
    v_rcp_f32 v51, v51
    v_mul_f32 v44, v44, v48
    v_mul_f32 v45, v45, v49
    v_mul_f32 v46, v46, v50
    v_mul_f32 v47, v47, v51
    v_cvt_pk_bf16_f32 v48, v44, v45
    v_cvt_pk_bf16_f32 v49, v46, v47
    v_cvt_pk_bf16_f32 v50, v44, v45
    v_cvt_pk_bf16_f32 v51, v46, v47
    s_nop 0
    v_permlane16_swap_b32 v48, v50
    v_permlane16_swap_b32 v49, v51
    s_mov_b32 exec_lo, 3
    s_mov_b32 exec_hi, 3
    buffer_store_dwordx4 v[48:51], v95, s[12:15], s24 offen sc1
    s_branch F_fin
F_c2:
    s_lshl_b32 s27, s23, 5
    v_lshrrev_b32 v15, 1, v13
    v_and_b32 v16, 1, v13
    v_lshlrev_b32 v131, 7, v15
    v_lshl_add_u32 v131, v16, 5, v131
    v_lshl_add_u32 v131, v14, 4, v131
    s_mul_i32 s26, s22, 3072
    s_add_u32 s26, s26, 2982144
    v_lshrrev_b32 v15, 1, v13
    v_and_b32 v16, 1, v13
    v_lshlrev_b32 v15, 9, v15
    v_lshl_add_u32 v15, v16, 7, v15
    v_lshl_add_u32 v15, v14, 3, v15
    s_mul_i32 s24, s22, 12288
    s_add_u32 s24, s24, 103040
    v_add_u32 v128, s24, v15
    s_barrier
    ds_read_b32 v6, v21 offset:8512
    s_waitcnt lgkmcnt(0)
    v_and_b32 v7, 0x7ff, v6
    v_sub_u32 v7, 0x7ff, v7
    v_mul_u32_u24 v132, 1280, v7
    v_lshl_add_u32 v132, v13, 3, v132
    ds_read_b64_tr_b16 v[72:73], v128 offset:0
    ds_read_b64_tr_b16 v[74:75], v128 offset:256
    ds_read_b64_tr_b16 v[76:77], v128 offset:1024
    ds_read_b64_tr_b16 v[78:79], v128 offset:1280
    ds_read_b64_tr_b16 v[80:81], v128 offset:2048
    ds_read_b64_tr_b16 v[82:83], v128 offset:2304
    ds_read_b64_tr_b16 v[84:85], v128 offset:3072
    ds_read_b64_tr_b16 v[86:87], v128 offset:3328
    ds_read_b64_tr_b16 v[88:89], v128 offset:4096
    ds_read_b64_tr_b16 v[90:91], v128 offset:4352
    ds_read_b64_tr_b16 v[92:93], v128 offset:5120
    ds_read_b64_tr_b16 v[94:95], v128 offset:5376
    ds_read_b64_tr_b16 v[96:97], v128 offset:6144
    ds_read_b64_tr_b16 v[98:99], v128 offset:6400
    ds_read_b64_tr_b16 v[100:101], v128 offset:7168
    ds_read_b64_tr_b16 v[102:103], v128 offset:7424
    ds_read_b64_tr_b16 v[104:105], v128 offset:8192
    ds_read_b64_tr_b16 v[106:107], v128 offset:8448
    ds_read_b64_tr_b16 v[108:109], v128 offset:9216
    ds_read_b64_tr_b16 v[110:111], v128 offset:9472
    ds_read_b64_tr_b16 v[112:113], v128 offset:10240
    ds_read_b64_tr_b16 v[114:115], v128 offset:10496
    ds_read_b64_tr_b16 v[116:117], v128 offset:11264
    ds_read_b64_tr_b16 v[118:119], v128 offset:11520
    v_ashrrev_i32 v10, 31, v6
    v_not_b32 v10, v10
    v_or_b32 v10, 0x80000000, v10
    v_xor_b32 v10, v10, v6
    v_mul_f32 v10, 0xbfb8aa3b, v10
    v_exp_f32 v10, v10
    v_lshlrev_b32 v130, 4, v12
    s_lshl_b32 s25, s22, 10
    v_add_f32 v10, 1.0, v10
    v_add_u32 v129, s25, v130
    v_rcp_f32 v10, v10
    s_mov_b32 s42, 131072
    s_mov_b64 exec, s[36:37]
C2_poll:
    buffer_load_dwordx2 v[182:183], v132, s[16:19], s27 offen sc1
    buffer_load_dwordx4 v[24:27], v131, s[12:15], s26 offen offset:0 sc1
    buffer_load_dwordx4 v[28:31], v131, s[12:15], s26 offen offset:256 sc1
    buffer_load_dwordx4 v[32:35], v131, s[12:15], s26 offen offset:512 sc1
    buffer_load_dwordx4 v[36:39], v131, s[12:15], s26 offen offset:768 sc1
    buffer_load_dwordx4 v[40:43], v131, s[12:15], s26 offen offset:1024 sc1
    buffer_load_dwordx4 v[44:47], v131, s[12:15], s26 offen offset:1280 sc1
    buffer_load_dwordx4 v[48:51], v131, s[12:15], s26 offen offset:1536 sc1
    buffer_load_dwordx4 v[52:55], v131, s[12:15], s26 offen offset:1792 sc1
    buffer_load_dwordx4 v[56:59], v131, s[12:15], s26 offen offset:2048 sc1
    buffer_load_dwordx4 v[60:63], v131, s[12:15], s26 offen offset:2304 sc1
    buffer_load_dwordx4 v[64:67], v131, s[12:15], s26 offen offset:2560 sc1
    buffer_load_dwordx4 v[68:71], v131, s[12:15], s26 offen offset:2816 sc1
    s_waitcnt vmcnt(0)
    v_max3_u32 v15, v24, v28, v32
    v_max3_u32 v15, v15, v36, v40
    v_max3_u32 v15, v15, v44, v48
    v_max3_u32 v15, v15, v52, v56
    v_max3_u32 v15, v15, v60, v64
    v_max3_u32 v15, v15, v68, v182
    v_cmp_eq_u32 vcc, -1, v15
    s_sub_u32 s42, s42, 1
    s_cselect_b64 vcc, 0, vcc
    s_cbranch_vccz C2_poll_x
    s_mov_b64 exec, vcc
    s_branch C2_poll
C2_poll_x:
    s_mov_b64 exec, -1
    s_mov_b64 exec, -1
    v_mov_b32 v8, v182
    v_mov_b32 v9, v183
    s_waitcnt lgkmcnt(0)
    v_mfma_f32_16x16x32_bf16 v[120:123], v[72:75], v[24:27], 0
    v_mfma_f32_16x16x32_bf16 v[124:127], v[76:79], v[28:31], 0
    v_mfma_f32_16x16x32_bf16 v[120:123], v[80:83], v[32:35], v[120:123]
    v_mfma_f32_16x16x32_bf16 v[124:127], v[84:87], v[36:39], v[124:127]
    v_mfma_f32_16x16x32_bf16 v[120:123], v[88:91], v[40:43], v[120:123]
    v_mfma_f32_16x16x32_bf16 v[124:127], v[92:95], v[44:47], v[124:127]
    v_mfma_f32_16x16x32_bf16 v[120:123], v[96:99], v[48:51], v[120:123]
    v_mfma_f32_16x16x32_bf16 v[124:127], v[100:103], v[52:55], v[124:127]
    v_mfma_f32_16x16x32_bf16 v[120:123], v[104:107], v[56:59], v[120:123]
    v_mfma_f32_16x16x32_bf16 v[124:127], v[108:111], v[60:63], v[124:127]
    v_mfma_f32_16x16x32_bf16 v[120:123], v[112:115], v[64:67], v[120:123]
    v_mfma_f32_16x16x32_bf16 v[124:127], v[116:119], v[68:71], v[124:127]
    s_nop 7
    v_pk_add_f32 v[120:121], v[120:121], v[124:125]
    v_pk_add_f32 v[122:123], v[122:123], v[126:127]
    ds_write_b128 v129, v[120:123]
    s_waitcnt lgkmcnt(0)
    s_barrier
    s_cmp_lg_u32 s22, 0
    s_cbranch_scc1 F_fin
    ds_read_b128 v[72:75], v130 offset:0
    ds_read_b128 v[76:79], v130 offset:1024
    ds_read_b128 v[80:83], v130 offset:2048
    ds_read_b128 v[84:87], v130 offset:3072
    v_lshlrev_b32 v120, 16, v8
    v_and_b32 v121, 0xffff0000, v8
    v_lshlrev_b32 v122, 16, v9
    v_and_b32 v123, 0xffff0000, v9
    s_waitcnt lgkmcnt(0)
    v_pk_add_f32 v[72:73], v[72:73], v[76:77]
    v_pk_add_f32 v[80:81], v[80:81], v[84:85]
    v_pk_add_f32 v[72:73], v[72:73], v[80:81]
    v_pk_add_f32 v[74:75], v[74:75], v[78:79]
    v_pk_add_f32 v[82:83], v[82:83], v[86:87]
    v_pk_add_f32 v[74:75], v[74:75], v[82:83]
    v_fmac_f32 v120, v10, v72
    v_fmac_f32 v121, v10, v73
    v_fmac_f32 v122, v10, v74
    v_fmac_f32 v123, v10, v75
    v_cvt_pk_bf16_f32 v8, v120, v121
    v_cvt_pk_bf16_f32 v9, v122, v123
    s_mov_b64 exec, s[36:37]
    buffer_store_dwordx2 v[8:9], v132, s[16:19], s27 offen
F_fin:
F_end:
    s_endpgm
F_sync:
    v_and_b32 v3, 63, v0
    v_lshlrev_b32 v24, 6, v3
    v_lshlrev_b32 v25, 6, v3
    s_lshl_b32 s25, s2, 6
    s_add_u32 s25, s25, 2998532
    s_load_dword s29, s[6:7], s25
    v_lshrrev_b32 v4, 4, v3
    s_lshl_b32 s24, s21, 2
    v_add_u32 v4, s24, v4
    s_cmp_eq_u32 s20, 0
    s_cselect_b32 s25, 5, 6
    v_lshlrev_b32 v4, s25, v4
    v_add_u32 v4, s20, v4
    v_sub_u32 v5, 2048, v4
    v_bfe_u32 v6, v3, 3, 1
    v_cmp_eq_u32 vcc, 1, v6
    s_nop 1
    v_cndmask_b32 v14, v4, v5, vcc
    v_mov_b32 v5, 1024
    v_cmp_eq_u32 vcc, 2048, v14
    s_nop 1
    v_cndmask_b32 v14, v14, v5, vcc
    v_and_b32 v6, 7, v3
    v_mul_u32_u24 v4, 1280, v14
    v_lshl_add_u32 v4, v6, 4, v4
    v_lshlrev_b32 v5, 7, v14
    v_lshlrev_b32 v7, 2, v3
    v_mov_b32 v16, 0
    v_mov_b32 v17, 0
    v_mov_b32 v10, -1
    v_mov_b32 v11, -1
    v_mov_b32 v12, -1
    v_mov_b32 v13, -1
    s_mov_b32 s24, 2719744
    s_mov_b32 exec_lo, 0x01010101
    s_mov_b32 exec_hi, 0x01010101
    buffer_store_dwordx2 v[10:11], v5, s[12:15], s24 offen sc1
    s_lshl_b32 s27, s2, 6
    s_lshl_b32 s28, s2, 6
    s_add_u32 s27, s27, 2998528
    s_add_u32 s28, s28, 2686976
    s_mov_b64 exec, 1
    buffer_store_dwordx2 v[16:17], v24, s[12:15], s28 offen sc1
    s_cmp_ge_u32 s2, 96
    s_cbranch_scc1 L_noact
    s_lshl_b32 s24, s23, 7
    s_add_u32 s24, s24, 2982144
    s_mov_b64 exec, 0xffff
    buffer_store_dword v10, v7, s[12:15], s24 offen sc1
L_noact:
    s_mov_b64 exec, -1
    v_mov_b32 v9, 152192
    s_mov_b64 exec, 1
    ds_write_b32 v9, v16
    s_waitcnt lgkmcnt(0)
    s_barrier
    s_add_u32 s29, s29, 0x9e3779b9
    v_mov_b32 v26, s29
    s_mov_b32 s29, 0x9e3779b9
    s_waitcnt vmcnt(0)
    s_mov_b32 s24, 2998528
    s_barrier
    buffer_store_dword v26, v24, s[12:15], s27 offen sc1
    s_mov_b64 exec, -1
    s_mov_b32 s42, 131072
    s_barrier
F_poll:
    s_mov_b32 s26, 2998528
    buffer_load_dwordx2 v[38:39], v24, s[12:15], s26 offen sc1
    s_mov_b32 s26, 3002624
    buffer_load_dwordx2 v[40:41], v24, s[12:15], s26 offen sc1
    s_mov_b32 s26, 3006720
    buffer_load_dwordx2 v[42:43], v24, s[12:15], s26 offen sc1
    s_mov_b32 s26, 3010816
    buffer_load_dwordx2 v[44:45], v24, s[12:15], s26 offen sc1
    s_waitcnt vmcnt(0)
    v_xad_u32 v16, v39, -1, v38
    v_xad_u32 v17, v41, -1, v40
    v_xad_u32 v18, v43, -1, v42
    v_xad_u32 v19, v45, -1, v44
    v_xor_b32 v16, 0x9e3779b8, v16
    v_xor_b32 v17, 0x9e3779b8, v17
    v_xor_b32 v18, 0x9e3779b8, v18
    v_xor_b32 v19, 0x9e3779b8, v19
    v_or3_b32 v16, v16, v17, v18
    v_or_b32 v16, v16, v19
    v_cmp_ne_u32 vcc, 0, v16
    s_sub_u32 s42, s42, 1
    s_cselect_b64 vcc, 0, vcc
    s_cbranch_vccz F_poll_x
    s_mov_b64 exec, vcc
    s_branch F_poll
F_poll_x:
    s_mov_b64 exec, -1
F_ok:
    v_mov_b32 v26, 1
    ds_write_b32 v9, v26
    v_mov_b32 v9, 8448
    s_waitcnt vmcnt(0) lgkmcnt(0)
    s_barrier
    s_barrier
    s_barrier
    ds_read_b128 v[16:19], v9
    ds_read_b128 v[20:23], v9 offset:16
    s_mov_b32 s24, 2686976
    s_waitcnt lgkmcnt(0)
    v_max_u32 v4, v16, v17
    v_min_u32 v17, v16, v17
    v_mov_b32 v16, v4
    v_max_u32 v4, v18, v19
    v_min_u32 v19, v18, v19
    v_mov_b32 v18, v4
    v_max_u32 v4, v20, v21
    v_min_u32 v21, v20, v21
    v_mov_b32 v20, v4
    v_max_u32 v4, v22, v23
    v_min_u32 v23, v22, v23
    v_mov_b32 v22, v4
    v_max_u32 v4, v17, v19
    v_med3_u32 v17, v16, v18, v4
    v_max_u32 v16, v16, v18
    v_max_u32 v5, v21, v23
    v_med3_u32 v21, v20, v22, v5
    v_max_u32 v20, v20, v22
    v_max_u32 v4, v17, v21
    v_med3_u32 v17, v16, v20, v4
    v_max_u32 v16, v16, v20
    s_mov_b64 exec, 1
    buffer_store_dwordx2 v[16:17], v24, s[12:15], s28 offen sc1
    s_mov_b64 exec, -1
    s_waitcnt vmcnt(0)
    s_barrier
    s_cmp_ge_u32 s2, 136
    s_cbranch_scc1 L_exit
    s_mov_b32 s42, 131072
C_poll:
    s_mov_b32 s26, 2686976
    buffer_load_dwordx2 v[16:17], v25, s[12:15], s26 offen sc1
    s_mov_b32 s26, 2691072
    buffer_load_dwordx2 v[18:19], v25, s[12:15], s26 offen sc1
    s_mov_b32 s26, 2695168
    buffer_load_dwordx2 v[20:21], v25, s[12:15], s26 offen sc1
    s_mov_b32 s26, 2699264
    buffer_load_dwordx2 v[22:23], v25, s[12:15], s26 offen sc1
    s_waitcnt vmcnt(0)
    v_min3_u32 v4, v17, v19, v21
    v_min_u32 v4, v4, v23
    v_cmp_eq_u32 vcc, 0, v4
    s_sub_u32 s42, s42, 1
    s_cselect_b64 vcc, 0, vcc
    s_cbranch_vccz C_poll_x
    s_mov_b64 exec, vcc
    s_branch C_poll
C_poll_x:
    s_mov_b64 exec, -1
C_ok:
    v_max_u32 v4, v17, v19
    v_med3_u32 v17, v16, v18, v4
    v_max_u32 v16, v16, v18
    v_max_u32 v5, v21, v23
    v_med3_u32 v21, v20, v22, v5
    v_max_u32 v20, v20, v22
    v_max_u32 v4, v17, v21
    v_med3_u32 v17, v16, v20, v4
    v_max_u32 v16, v16, v20
    s_nop 1
    v_mov_b32_dpp v18, v16 row_ror:8 row_mask:0xf bank_mask:0xf
    v_mov_b32_dpp v19, v17 row_ror:8 row_mask:0xf bank_mask:0xf
    v_max_u32 v4, v17, v19
    v_med3_u32 v17, v16, v18, v4
    v_max_u32 v16, v16, v18
    s_nop 1
    v_mov_b32_dpp v18, v16 row_ror:4 row_mask:0xf bank_mask:0xf
    v_mov_b32_dpp v19, v17 row_ror:4 row_mask:0xf bank_mask:0xf
    v_max_u32 v4, v17, v19
    v_med3_u32 v17, v16, v18, v4
    v_max_u32 v16, v16, v18
    s_nop 1
    v_mov_b32_dpp v18, v16 row_ror:2 row_mask:0xf bank_mask:0xf
    v_mov_b32_dpp v19, v17 row_ror:2 row_mask:0xf bank_mask:0xf
    v_max_u32 v4, v17, v19
    v_med3_u32 v17, v16, v18, v4
    v_max_u32 v16, v16, v18
    s_nop 1
    v_mov_b32_dpp v18, v16 row_ror:1 row_mask:0xf bank_mask:0xf
    v_mov_b32_dpp v19, v17 row_ror:1 row_mask:0xf bank_mask:0xf
    v_max_u32 v4, v17, v19
    v_med3_u32 v17, v16, v18, v4
    v_max_u32 v16, v16, v18
    v_mov_b32 v18, v16
    v_mov_b32 v19, v17
    s_nop 0
    v_permlane16_swap_b32 v16, v18
    v_permlane16_swap_b32 v17, v19
    v_max_u32 v4, v17, v19
    v_med3_u32 v17, v16, v18, v4
    v_max_u32 v16, v16, v18
    v_mov_b32 v18, v16
    v_mov_b32 v19, v17
    s_nop 0
    v_permlane32_swap_b32 v16, v18
    v_permlane32_swap_b32 v17, v19
    v_max_u32 v4, v17, v19
    v_med3_u32 v17, v16, v18, v4
    v_max_u32 v16, v16, v18
    ds_write_b64 v9, v[16:17] offset:64
    s_waitcnt lgkmcnt(0)
    s_barrier
    s_cmp_lg_u32 s2, 135
    s_cbranch_scc1 L_exit
    s_mov_b32 s26, 2998532
    buffer_store_dword v38, v24, s[12:15], s26 offen sc1
    s_mov_b32 s26, 3002628
    buffer_store_dword v40, v24, s[12:15], s26 offen sc1
    s_mov_b32 s26, 3006724
    buffer_store_dword v42, v24, s[12:15], s26 offen sc1
    s_mov_b32 s26, 3010820
    buffer_store_dword v44, v24, s[12:15], s26 offen sc1
L_exit:
    s_waitcnt vmcnt(0)
    s_endpgm
F_loader:
    s_load_dwordx4 s[56:59], s[0:1], 56
    s_load_dwordx2 s[60:61], s[0:1], 72
    v_and_b32 v3, 63, v0
    v_lshrrev_b32 v4, 4, v3
    s_lshl_b32 s24, s21, 2
    v_add_u32 v4, s24, v4
    s_cmp_eq_u32 s20, 0
    s_cselect_b32 s25, 5, 6
    v_lshlrev_b32 v4, s25, v4
    v_add_u32 v4, s20, v4
    v_sub_u32 v5, 2048, v4
    v_bfe_u32 v6, v3, 3, 1
    v_cmp_eq_u32 vcc, 1, v6
    s_nop 1
    v_cndmask_b32 v10, v4, v5, vcc
    v_mov_b32 v5, 1024
    v_cmp_eq_u32 vcc, 2048, v10
    s_nop 1
    v_cndmask_b32 v10, v10, v5, vcc
    v_and_b32 v6, 7, v3
    v_mul_u32_u24 v4, 1280, v10
    v_lshl_add_u32 v4, v6, 4, v4
    v_lshlrev_b32 v7, 4, v3
    s_mov_b32 m0, 113280
    v_mov_b32 v26, v4
    v_mov_b32 v32, 152192
    v_mov_b32 v28, -1
    v_mov_b32 v29, -1
    v_mov_b32 v30, -1
    v_mov_b32 v31, -1
    v_bfe_u32 v35, v3, 2, 2
    v_add_u32 v35, 16, v35
    v_lshrrev_b32 v34, 4, v3
    s_lshl_b32 s24, s21, 2
    v_lshl_add_u32 v34, v34, 5, s24
    v_and_b32 v37, 3, v3
    v_add_u32 v34, v34, v37
    v_cvt_f32_u32 v35, v35
    v_cvt_f32_u32 v36, v34
    v_mul_f32 v35, 0x3acccccd, v35
    v_mul_f32 v36, v35, v36
    v_lshlrev_b32 v34, 4, v3
    v_fmamk_f32 v46, v35, 0x0, v36
    v_fmamk_f32 v47, v35, 0x43000000, v36
    v_fmamk_f32 v48, v35, 0x43800000, v36
    v_fmamk_f32 v49, v35, 0x43c00000, v36
    v_fmamk_f32 v50, v35, 0x44000000, v36
    v_mov_b32 v41, 0
    v_mov_b32 v45, 0
    v_sin_f32 v52, v46
    v_sin_f32 v53, v47
    v_sin_f32 v54, v48
    v_sin_f32 v55, v49
    v_sin_f32 v56, v50
    v_cos_f32 v46, v46
    v_cos_f32 v47, v47
    v_cos_f32 v48, v48
    v_cos_f32 v49, v49
    v_cos_f32 v50, v50
    v_cvt_pk_bf16_f32 v42, v52, v53
    v_cvt_pk_bf16_f32 v43, v54, v55
    v_cvt_pk_bf16_f32 v44, v56, 0
    v_cvt_pk_bf16_f32 v38, v46, v47
    v_cvt_pk_bf16_f32 v39, v48, v49
    v_cvt_pk_bf16_f32 v40, v50, 0
    ds_write_b128 v34, v[38:41] offset:36864
    ds_write_b128 v34, v[42:45] offset:37888
    s_waitcnt lgkmcnt(0)
    buffer_load_dwordx4 v7, s[44:47], 0 offen offset:0 lds
    buffer_load_dwordx4 v7, s[44:47], 0 offen offset:1024 lds
    s_mov_b32 m0, 103040
    s_nop 0
    buffer_load_dwordx4 v4, s[8:11], 0 offen offset:0 lds
    s_mov_b32 m0, 103936
    s_nop 0
    buffer_load_dwordx4 v4, s[8:11], 0 offen offset:128 lds
    s_mov_b32 m0, 104832
    s_nop 0
    buffer_load_dwordx4 v4, s[8:11], 0 offen offset:256 lds
    s_mov_b32 m0, 105728
    s_nop 0
    buffer_load_dwordx4 v4, s[8:11], 0 offen offset:384 lds
    s_mov_b32 m0, 106624
    s_nop 0
    buffer_load_dwordx4 v4, s[8:11], 0 offen offset:512 lds
    s_mov_b32 m0, 107520
    s_nop 0
    buffer_load_dwordx4 v4, s[8:11], 0 offen offset:640 lds
    s_mov_b32 m0, 108416
    s_nop 0
    buffer_load_dwordx4 v4, s[8:11], 0 offen offset:768 lds
    s_mov_b32 m0, 109312
    s_nop 0
    buffer_load_dwordx4 v4, s[8:11], 0 offen offset:896 lds
    s_mov_b32 m0, 110208
    s_nop 0
    buffer_load_dwordx4 v4, s[8:11], 0 offen offset:1024 lds
    s_mov_b32 m0, 111104
    s_nop 0
    buffer_load_dwordx4 v4, s[8:11], 0 offen offset:1152 lds
    v_mul_u32_u24 v4, 21846, v3
    v_lshrrev_b32 v4, 16, v4
    v_mul_u32_u24 v5, 2880, v4
    v_lshl_add_u32 v11, v3, 6, v5
    v_mul_u32_u24 v12, 1280, v3
    s_lshr_b32 s24, s2, 3
    s_and_b32 s25, s2, 7
    s_mul_i32 s29, s24, 61440
    s_mul_i32 s30, s25, 384
    s_add_u32 s29, s29, s30
    s_mul_i32 s30, s24, 61440
    s_mul_i32 s25, s25, 160
    s_and_b32 s25, s25, -64
    s_add_u32 s30, s30, s25
    s_cmp_lt_u32 s2, 96
    s_cselect_b32 s31, 12, 5
    s_lshl_b32 s31, s31, 8
    v_lshrrev_b32 v4, 1, v3
    v_and_b32 v5, 0x13, v4
    v_and_b32 v6, 4, v4
    v_lshl_or_b32 v5, v6, 1, v5
    v_and_b32 v6, 8, v4
    v_lshrrev_b32 v6, 1, v6
    v_or_b32 v5, v5, v6
    v_mul_u32_u24 v5, s31, v5
    v_and_b32 v6, 1, v3
    v_lshl_add_u32 v5, v6, 4, v5
    v_mov_b32 v13, v5
    s_waitcnt lgkmcnt(0)
    s_mov_b32 s32, s56
    s_and_b32 s33, s57, 0xffff
    s_mov_b32 s34, 1966080
    s_mov_b32 s35, 0x20000
    s_mov_b32 s36, s58
    s_and_b32 s37, s59, 0xffff
    s_mov_b32 s38, 1966080
    s_mov_b32 s39, 0x20000
    s_mov_b32 s52, s60
    s_and_b32 s53, s61, 0xffff
    s_mov_b32 s54, 1966080
    s_mov_b32 s55, 0x20000
    s_mov_b32 exec_hi, 0x0fffffff
    buffer_load_dword v14, v11, s[32:35], s29 offen offset:0
    buffer_load_dword v15, v11, s[32:35], s29 offen offset:192
    buffer_load_dword v16, v11, s[36:39], s29 offen offset:0
    buffer_load_dword v17, v11, s[36:39], s29 offen offset:192
    s_mov_b32 exec_hi, 0xffff
    buffer_load_dword v18, v12, s[52:55], s30 offen offset:0
    buffer_load_dword v19, v12, s[52:55], s30 offen offset:64
    buffer_load_dword v20, v12, s[52:55], s30 offen offset:128
    s_mov_b32 exec_hi, -1
    s_lshl_b32 s24, s23, 5
    s_mov_b32 s25, 103040
    s_barrier
    s_waitcnt vmcnt(7)
    s_barrier
    s_barrier
    buffer_store_dwordx4 v[28:31], v26, s[16:19], 0 offen offset:0 sc1
    buffer_store_dwordx4 v[28:31], v26, s[16:19], 0 offen offset:128 sc1
    buffer_store_dwordx4 v[28:31], v26, s[16:19], 0 offen offset:256 sc1
    buffer_store_dwordx4 v[28:31], v26, s[16:19], 0 offen offset:384 sc1
    buffer_store_dwordx4 v[28:31], v26, s[16:19], 0 offen offset:512 sc1
    buffer_store_dwordx4 v[28:31], v26, s[16:19], 0 offen offset:640 sc1
    buffer_store_dwordx4 v[28:31], v26, s[16:19], 0 offen offset:768 sc1
    buffer_store_dwordx4 v[28:31], v26, s[16:19], 0 offen offset:896 sc1
    buffer_store_dwordx4 v[28:31], v26, s[16:19], 0 offen offset:1024 sc1
    buffer_store_dwordx4 v[28:31], v26, s[16:19], 0 offen offset:1152 sc1
    s_barrier
    s_waitcnt vmcnt(0)
    s_cmp_ge_u32 s2, 96
    s_cbranch_scc1 L_not1
L_loop1:
    s_mov_b32 m0, s25
    s_add_u32 s26, s25, 20480
    buffer_load_dwordx4 v13, s[32:35], s24 offen sc1 lds
    s_mov_b32 m0, s26
    s_add_u32 s25, s25, 1024
    buffer_load_dwordx4 v13, s[36:39], s24 offen sc1 lds
    s_add_u32 s24, s24, 98304
    s_cmp_lt_u32 s25, 123520
    s_cbranch_scc1 L_loop1
L_not1:
    s_barrier
    s_barrier
    s_barrier
    s_sub_u32 s26, s2, 96
    s_cmp_ge_u32 s26, 40
    s_cbranch_scc1 L_not2
L_loop2:
    s_mov_b32 m0, s25
    s_add_u32 s25, s25, 1024
    buffer_load_dwordx4 v13, s[52:55], s24 offen sc1 lds
    s_add_u32 s24, s24, 40960
    s_cmp_lt_u32 s25, 152192
    s_cbranch_scc1 L_loop2
L_not2:
    s_cmp_ge_u32 s2, 136
    s_cbranch_scc1 L_fin
    s_waitcnt vmcnt(0)
    s_barrier
L_fin:
    s_waitcnt vmcnt(0)
    s_endpgm
.section .rodata,"a"
.p2align 6
.amdhsa_kernel sequential_preLN__spectral_fnet__moe_arch_mod__prompt_kernel
  .amdhsa_next_free_vgpr 254
  .amdhsa_next_free_sgpr 96
  .amdhsa_accum_offset 256
  .amdhsa_group_segment_fixed_size 0
  .amdhsa_kernarg_size 104
  .amdhsa_user_sgpr_count 2
  .amdhsa_user_sgpr_kernarg_segment_ptr 1
  .amdhsa_system_sgpr_workgroup_id_x 1
.end_amdhsa_kernel
```
